```python
import torch

def _softmax(x, axis=-1):
    return torch.softmax(x, dim=axis)
def _gelu(x):
    return torch.nn.functional.gelu(x, approximate="tanh")
def _silu(x):
    return torch.nn.functional.silu(x)
def _sigmoid(x):
    return torch.sigmoid(x)
def _layernorm(x, axis=-1, eps=1e-5):
    m = x.mean(dim=axis, keepdim=True)
    v = x.var(dim=axis, keepdim=True, unbiased=False)
    return (x - m) / torch.sqrt(v + eps)
def _scatter_add(tgt, idx, src, axis=0):
    return tgt.clone().index_add_(axis, idx, src)
def _segment_sum(src, seg, n):
    out = torch.zeros((n,) + src.shape[1:], dtype=src.dtype)
    return out.index_add_(0, seg, src)
def _pad(x, pw):
    flat = tuple(v for pair in reversed(pw) for v in pair)
    return torch.nn.functional.pad(x, flat)

kernel_name = 'sequential_preLN__mha_block_cached__geglu_ffn__decode'

def setup_inputs():

    _w = (lambda a: (lambda t: t.to(torch.bfloat16) if t.is_floating_point() else t)(torch.as_tensor(a)))
    def _A_setup():
        B, Sq, D = 8, 1, 1024
        H, Sk, Dh = 32, 4096, 128
        return {
            "x": _w((lambda *s: torch.randn(*s, dtype=torch.bfloat16) * 0.05)(B, Sq, D)),
            "k_cache": _w((lambda *s: torch.randn(*s, dtype=torch.bfloat16) * 3.2)(B, H, Sk, Dh)),
            "v_cache": _w((lambda *s: torch.randn(*s, dtype=torch.bfloat16) * 0.4)(B, H, Sk, Dh)),
            "wq": _w((lambda *s: torch.randn(*s, dtype=torch.bfloat16) * 3.2)(D, H * Dh) * (D ** -0.5)),
            "wo": _w((lambda *s: torch.randn(*s, dtype=torch.bfloat16) * 0.4)(H * Dh, D) * ((H * Dh) ** -0.5)),
        }
    _A_in = _A_setup()

    def _B_setup():
        B, S, D, F = 8, 1, 1024, 3584
        return {
            "x": _w((lambda *s: torch.randn(*s, dtype=torch.bfloat16) * 0.05)(B, S, D)),
            "w_gate": _w((lambda *s: torch.randn(*s, dtype=torch.bfloat16) * 0.05)(D, F)),
            "w_up": _w((lambda *s: torch.randn(*s, dtype=torch.bfloat16) * 0.05)(D, F)),
            "w_down": _w((lambda *s: torch.randn(*s, dtype=torch.bfloat16) * 0.05)(F, D)),
        }
    _B_in = _B_setup()

    return {
        "A_x": _A_in["x"],
        "A_k_cache": _A_in["k_cache"],
        "A_v_cache": _A_in["v_cache"],
        "A_wq": _A_in["wq"],
        "A_wo": _A_in["wo"],
        "B_x": _B_in["x"],
        "B_w_gate": _B_in["w_gate"],
        "B_w_up": _B_in["w_up"],
        "B_w_down": _B_in["w_down"],
    }

def reference(A_x, A_k_cache, A_v_cache, A_wq, A_wo, B_x, B_w_gate, B_w_up, B_w_down):
    def _A_ref(x, k_cache, v_cache, wq, wo):
        B, Sq, D = x.shape
        H, Dh = 32, 128
        q = (lambda x, *d: x.permute(*d))((x @ wq).reshape(B, Sq, H, Dh), 0, 2, 1, 3)
        scores = torch.einsum("bhqd,bhkd->bhqk", q, k_cache) * (Dh ** -0.5)
        p = _softmax(scores, axis=-1)
        o = torch.einsum("bhqk,bhkd->bhqd", p, v_cache)
        return (lambda x, *d: x.permute(*d))(o, 0, 2, 1, 3).reshape(B, Sq, H * Dh) @ wo

    def _B_ref(x, w_gate, w_up, w_down):
        return (_gelu(x @ w_gate) * (x @ w_up)) @ w_down

    x = A_x
    h = x + _A_ref(_layernorm(x, axis=-1), A_k_cache, A_v_cache, A_wq, A_wo)
    h2 = h + _B_ref(_layernorm(h, axis=-1), B_w_gate, B_w_up, B_w_down)
    return h2
```

```asm
; @launch grid=(256,1,1) block=(512,1,1) lds=163840
.amdgcn_target "amdgcn-amd-amdhsa--gfx950"
.text
.globl sequential_preLN__mha_block_cached__geglu_ffn__decode_kernel
.p2align 8
.type sequential_preLN__mha_block_cached__geglu_ffn__decode_kernel,@function
sequential_preLN__mha_block_cached__geglu_ffn__decode_kernel:
  s_cmp_ge_u32 s2, 256
  s_cbranch_scc1 L_exit
  s_load_dwordx16 s[16:31], s[0:1], 0
  s_load_dwordx8 s[32:39], s[0:1], 64
  s_getpc_b64 s[60:61]
L_pf0:
  s_add_u32 s60, s60, sequential_preLN__mha_block_cached__geglu_ffn__decode_kernel-L_pf0
  s_addc_u32 s61, s61, -1
  v_lshlrev_b32 v10, 6, v0
  v_cmp_gt_u32 vcc, L_codeend-sequential_preLN__mha_block_cached__geglu_ffn__decode_kernel, v10
  s_and_saveexec_b64 s[62:63], vcc
  s_cbranch_execz L_pf0_done
  global_load_dword v15, v10, s[60:61]
L_pf0_done:
  s_mov_b64 exec, s[62:63]
  v_lshrrev_b32 v2, 6, v0
  v_and_b32 v1, 63, v0
  s_and_b32 s4, s2, 7
  v_readfirstlane_b32 s3, v2
  s_lshr_b32 s5, s2, 3
  s_lshr_b32 s52, s5, 3
  s_lshl_b32 s6, s4, 2
  s_add_u32 s6, s6, s52
  s_and_b32 s7, s5, 7
  s_lshl_b32 s65, s52, 3
  s_add_u32 s65, s65, s4
  v_and_b32 v2, 15, v1
  v_lshrrev_b32 v3, 4, v1
  v_lshlrev_b32 v21, 4, v1
  v_lshrrev_b32 v4, 2, v2
  v_and_b32 v5, 3, v2
  v_lshlrev_b32 v6, 8, v4
  v_lshlrev_b32 v7, 6, v3
  v_lshlrev_b32 v8, 4, v5
  v_add3_u32 v20, v6, v7, v8
  v_mov_b32 v25, 0
  s_waitcnt lgkmcnt(0)
  s_load_dwordx2 s[66:67], s[38:39], 65536
  s_lshl_b32 s52, s7, 5
  s_add_u32 s52, s52, s65
  s_lshl_b32 s52, s52, 20
  s_add_u32 s40, s18, s52
  s_addc_u32 s41, s19, 0
  s_and_b32 s41, s41, 0xffff
  s_mov_b32 s42, 0x100000
  s_mov_b32 s43, 0x20000
  s_add_u32 s44, s20, s52
  s_addc_u32 s45, s21, 0
  s_and_b32 s45, s45, 0xffff
  s_mov_b32 s46, 0x100000
  s_mov_b32 s47, 0x20000
  s_lshl_b32 s52, s3, 11
  v_lshlrev_b32 v9, 5, v1
  v_add_u32 v9, s52, v9
  global_load_dwordx4 v[160:163], v9, s[16:17]
  global_load_dwordx4 v[164:167], v9, s[16:17] offset:16
  s_cmp_lt_u32 s3, 4
  s_cbranch_scc1 L_lowwaves
L_high:
  v_lshrrev_b32 v10, 3, v1
  v_and_b32 v11, 7, v1
  v_lshlrev_b32 v11, 4, v11
  s_lshr_b32 s56, s5, 4
  s_and_b32 s57, s5, 15
  s_cmp_eq_u32 s3, 4
  s_cbranch_scc1 L_dma_wo
  s_cmp_eq_u32 s3, 7
  s_cbranch_scc1 L_dma_wd
  s_cmp_ge_u32 s5, 28
  s_cbranch_scc1 L_dma_done
  s_mul_i32 s52, s5, 37
  s_lshr_b32 s52, s52, 8
  s_mul_i32 s53, s52, 7
  s_sub_u32 s53, s5, s53
  s_mul_i32 s52, s52, 1835008
  s_mul_i32 s54, s4, 896
  s_lshl_b32 s53, s53, 7
  s_add_u32 s52, s52, s54
  s_add_u32 s52, s52, s53
  s_cmp_eq_u32 s3, 5
  s_cselect_b32 s58, s28, s30
  s_cselect_b32 s59, s29, s31
  s_mov_b32 s55, 65536
  s_cselect_b32 s55, 32768, s55
  s_add_u32 s58, s58, s52
  s_addc_u32 s59, s59, 0
  s_mov_b32 s52, 7168
  s_mov_b32 s53, 32
  s_branch L_dma_go
L_dma_wo:
  s_lshl_b32 s52, s56, 4
  s_add_u32 s52, s52, s4
  s_lshl_b32 s52, s52, 18
  s_lshl_b32 s53, s57, 7
  s_add_u32 s52, s52, s53
  s_add_u32 s58, s24, s52
  s_addc_u32 s59, s25, 0
  s_mov_b32 s55, 0
  s_mov_b32 s52, 2048
  s_mov_b32 s53, 32
  s_branch L_dma_go
L_dma_wd:
  s_lshl_b32 s52, s4, 1
  s_add_u32 s52, s52, s56
  s_mul_i32 s52, s52, 458752
  s_lshl_b32 s53, s57, 7
  s_add_u32 s52, s52, s53
  s_add_u32 s58, s32, s52
  s_addc_u32 s59, s33, 0
  s_mov_b32 s55, 98304
  s_mov_b32 s52, 2048
  s_mov_b32 s53, 28
L_dma_go:
  v_mul_lo_u32 v10, v10, s52
  s_lshl_b32 s52, s52, 3
  v_add_u32 v10, v10, v11
  s_mov_b32 m0, s55
  s_nop 0
  global_load_lds_dwordx4 v10, s[58:59] nt
  s_add_u32 m0, m0, 1024
  s_add_u32 s58, s58, s52
  s_addc_u32 s59, s59, 0
  global_load_lds_dwordx4 v10, s[58:59] nt
  s_add_u32 m0, m0, 1024
  s_add_u32 s58, s58, s52
  s_addc_u32 s59, s59, 0
  global_load_lds_dwordx4 v10, s[58:59] nt
  s_add_u32 m0, m0, 1024
  s_add_u32 s58, s58, s52
  s_addc_u32 s59, s59, 0
  global_load_lds_dwordx4 v10, s[58:59] nt
  s_add_u32 m0, m0, 1024
  s_add_u32 s58, s58, s52
  s_addc_u32 s59, s59, 0
  s_sub_u32 s12, s53, 4
  s_mov_b32 s13, s52
  s_mov_b32 s14, 0
  s_cmp_eq_u32 s3, 4
  s_cselect_b32 s14, 1835008, 0
  v_mov_b32 v25, v10
  s_waitcnt vmcnt(4)
  s_branch L_ln1
L_dma_done:
  s_mov_b32 s12, 0
  s_mov_b32 s58, s38
  s_mov_b32 s59, s39
  v_mov_b32 v25, 0
  s_waitcnt vmcnt(0)
  s_branch L_ln1
L_lowwaves:
  v_lshlrev_b32 v12, 13, v3
  v_lshlrev_b32 v11, 1, v3
  v_xor_b32 v10, v2, v11
  v_xor_b32 v11, 8, v10
  v_lshl_add_u32 v10, v10, 4, v12
  v_lshl_add_u32 v11, v11, 4, v12
  s_lshl_b32 s52, s7, 7
  s_lshl_b32 s53, s3, 5
  s_add_u32 s52, s52, s53
  s_lshl_b32 s52, s52, 13
  s_lshl_b32 s53, s65, 8
  s_add_u32 s52, s52, s53
  s_add_u32 s58, s22, s52
  s_addc_u32 s59, s23, 0
  s_lshl_b32 s53, s3, 13
  s_add_u32 m0, s53, 126976
  s_nop 0
  global_load_lds_dwordx4 v10, s[58:59] nt
  s_add_u32 m0, m0, 1024
  s_add_u32 s58, s58, 32768
  s_addc_u32 s59, s59, 0
  global_load_lds_dwordx4 v10, s[58:59] nt
  s_add_u32 m0, m0, 1024
  s_add_u32 s58, s58, 32768
  s_addc_u32 s59, s59, 0
  global_load_lds_dwordx4 v11, s[58:59] nt
  s_add_u32 m0, m0, 1024
  s_add_u32 s58, s58, 32768
  s_addc_u32 s59, s59, 0
  global_load_lds_dwordx4 v11, s[58:59] nt
  s_add_u32 m0, m0, 1024
  s_add_u32 s58, s58, 32768
  s_addc_u32 s59, s59, 0
  global_load_lds_dwordx4 v10, s[58:59] nt
  s_add_u32 m0, m0, 1024
  s_add_u32 s58, s58, 32768
  s_addc_u32 s59, s59, 0
  global_load_lds_dwordx4 v10, s[58:59] nt
  s_add_u32 m0, m0, 1024
  s_add_u32 s58, s58, 32768
  s_addc_u32 s59, s59, 0
  global_load_lds_dwordx4 v11, s[58:59] nt
  s_add_u32 m0, m0, 1024
  s_add_u32 s58, s58, 32768
  s_addc_u32 s59, s59, 0
  global_load_lds_dwordx4 v11, s[58:59] nt
  s_cmp_ge_u32 s3, 2
  s_cbranch_scc1 L_low_nostr
  s_lshl_b32 s48, s3, 12
  buffer_load_dwordx4 v[96:99], v20, s[40:43], s48 offen offset:0 nt
  buffer_load_dwordx4 v[100:103], v20, s[40:43], s48 offen offset:1024 nt
  buffer_load_dwordx4 v[104:107], v20, s[40:43], s48 offen offset:2048 nt
  buffer_load_dwordx4 v[108:111], v20, s[40:43], s48 offen offset:3072 nt
  s_add_u32 s48, s48, 8192
  buffer_load_dwordx4 v[112:115], v20, s[40:43], s48 offen offset:0 nt
  buffer_load_dwordx4 v[116:119], v20, s[40:43], s48 offen offset:1024 nt
  buffer_load_dwordx4 v[120:123], v20, s[40:43], s48 offen offset:2048 nt
  buffer_load_dwordx4 v[124:127], v20, s[40:43], s48 offen offset:3072 nt
  s_add_u32 s48, s48, 8192
  buffer_load_dwordx4 v[128:131], v20, s[40:43], s48 offen offset:0 nt
  buffer_load_dwordx4 v[132:135], v20, s[40:43], s48 offen offset:1024 nt
  s_waitcnt vmcnt(18)
  s_branch L_ln1_low
L_low_nostr:
  s_waitcnt vmcnt(8)
L_ln1_low:
L_ln1:
  v_lshlrev_b32 v168, 16, v160
  v_and_b32 v169, 0xffff0000, v160
  v_lshlrev_b32 v170, 16, v161
  v_and_b32 v171, 0xffff0000, v161
  v_lshlrev_b32 v172, 16, v162
  v_and_b32 v173, 0xffff0000, v162
  v_lshlrev_b32 v174, 16, v163
  v_and_b32 v175, 0xffff0000, v163
  v_lshlrev_b32 v176, 16, v164
  v_and_b32 v177, 0xffff0000, v164
  v_lshlrev_b32 v178, 16, v165
  v_and_b32 v179, 0xffff0000, v165
  v_lshlrev_b32 v180, 16, v166
  v_and_b32 v181, 0xffff0000, v166
  v_lshlrev_b32 v182, 16, v167
  v_and_b32 v183, 0xffff0000, v167
  v_readfirstlane_b32 s56, v168
  s_nop 1
  v_mov_b32 v78, s56
  v_mov_b32 v79, s56
  v_pk_add_f32 v[168:169], v[168:169], v[78:79] neg_lo:[0,1] neg_hi:[0,1]
  v_pk_add_f32 v[170:171], v[170:171], v[78:79] neg_lo:[0,1] neg_hi:[0,1]
  v_pk_add_f32 v[172:173], v[172:173], v[78:79] neg_lo:[0,1] neg_hi:[0,1]
  v_pk_add_f32 v[174:175], v[174:175], v[78:79] neg_lo:[0,1] neg_hi:[0,1]
  v_pk_add_f32 v[176:177], v[176:177], v[78:79] neg_lo:[0,1] neg_hi:[0,1]
  v_pk_add_f32 v[178:179], v[178:179], v[78:79] neg_lo:[0,1] neg_hi:[0,1]
  v_pk_add_f32 v[180:181], v[180:181], v[78:79] neg_lo:[0,1] neg_hi:[0,1]
  v_pk_add_f32 v[182:183], v[182:183], v[78:79] neg_lo:[0,1] neg_hi:[0,1]
  v_pk_add_f32 v[72:73], v[168:169], v[170:171]
  v_pk_mul_f32 v[74:75], v[168:169], v[168:169]
  v_pk_fma_f32 v[74:75], v[170:171], v[170:171], v[74:75]
  v_pk_add_f32 v[72:73], v[72:73], v[172:173]
  v_pk_fma_f32 v[74:75], v[172:173], v[172:173], v[74:75]
  v_pk_add_f32 v[72:73], v[72:73], v[174:175]
  v_pk_fma_f32 v[74:75], v[174:175], v[174:175], v[74:75]
  v_pk_add_f32 v[72:73], v[72:73], v[176:177]
  v_pk_fma_f32 v[74:75], v[176:177], v[176:177], v[74:75]
  v_pk_add_f32 v[72:73], v[72:73], v[178:179]
  v_pk_fma_f32 v[74:75], v[178:179], v[178:179], v[74:75]
  v_pk_add_f32 v[72:73], v[72:73], v[180:181]
  v_pk_fma_f32 v[74:75], v[180:181], v[180:181], v[74:75]
  v_pk_add_f32 v[72:73], v[72:73], v[182:183]
  v_pk_fma_f32 v[74:75], v[182:183], v[182:183], v[74:75]
  v_add_f32 v72, v72, v73
  v_add_f32 v74, v74, v75
  s_nop 0
  v_add_f32_dpp v72, v72, v72 row_ror:8 row_mask:0xf bank_mask:0xf
  v_add_f32_dpp v74, v74, v74 row_ror:8 row_mask:0xf bank_mask:0xf
  s_nop 0
  v_add_f32_dpp v72, v72, v72 row_ror:4 row_mask:0xf bank_mask:0xf
  v_add_f32_dpp v74, v74, v74 row_ror:4 row_mask:0xf bank_mask:0xf
  s_nop 0
  v_add_f32_dpp v72, v72, v72 row_ror:2 row_mask:0xf bank_mask:0xf
  v_add_f32_dpp v74, v74, v74 row_ror:2 row_mask:0xf bank_mask:0xf
  s_nop 0
  v_add_f32_dpp v72, v72, v72 row_ror:1 row_mask:0xf bank_mask:0xf
  v_add_f32_dpp v74, v74, v74 row_ror:1 row_mask:0xf bank_mask:0xf
  v_mov_b32 v73, v72
  v_mov_b32 v75, v74
  s_nop 1
  v_permlane16_swap_b32 v72, v73
  v_permlane16_swap_b32 v74, v75
  s_nop 1
  v_add_f32 v72, v72, v73
  v_add_f32 v74, v74, v75
  v_mov_b32 v73, v72
  v_mov_b32 v75, v74
  s_nop 1
  v_permlane32_swap_b32 v72, v73
  v_permlane32_swap_b32 v74, v75
  s_nop 1
  v_add_f32 v72, v72, v73
  v_add_f32 v74, v74, v75
  v_mul_f32 v72, 0x3a800000, v72
  v_mul_f32 v74, 0x3a800000, v74
  v_fma_f32 v74, -v72, v72, v74
  v_add_f32 v72, v72, v78
  v_max_f32 v74, 0, v74
  v_cvt_pk_bf16_f32 v72, v72, v74
  v_and_b32 v74, 0xffff0000, v72
  v_lshlrev_b32 v72, 16, v72
  v_add_f32 v74, 0x3727c5ac, v74
  v_cvt_pk_bf16_f32 v74, v74, v74
  v_and_b32 v74, 0xffff0000, v74
  v_sqrt_f32 v74, v74
  v_mov_b32 v73, v72
  v_cvt_pk_bf16_f32 v74, v74, v74
  v_and_b32 v74, 0xffff0000, v74
  v_rcp_f32 v74, v74
  s_nop 0
  v_mov_b32 v75, v74
  v_lshlrev_b32 v168, 16, v160
  v_and_b32 v169, 0xffff0000, v160
  v_pk_add_f32 v[168:169], v[168:169], v[72:73] neg_lo:[0,1] neg_hi:[0,1]
  v_cvt_pk_bf16_f32 v76, v168, v169
  v_lshlrev_b32 v168, 16, v76
  v_and_b32 v169, 0xffff0000, v76
  v_pk_mul_f32 v[168:169], v[168:169], v[74:75]
  v_cvt_pk_bf16_f32 v184, v168, v169
  v_lshlrev_b32 v170, 16, v161
  v_and_b32 v171, 0xffff0000, v161
  v_pk_add_f32 v[170:171], v[170:171], v[72:73] neg_lo:[0,1] neg_hi:[0,1]
  v_cvt_pk_bf16_f32 v76, v170, v171
  v_lshlrev_b32 v170, 16, v76
  v_and_b32 v171, 0xffff0000, v76
  v_pk_mul_f32 v[170:171], v[170:171], v[74:75]
  v_cvt_pk_bf16_f32 v185, v170, v171
  v_lshlrev_b32 v172, 16, v162
  v_and_b32 v173, 0xffff0000, v162
  v_pk_add_f32 v[172:173], v[172:173], v[72:73] neg_lo:[0,1] neg_hi:[0,1]
  v_cvt_pk_bf16_f32 v76, v172, v173
  v_lshlrev_b32 v172, 16, v76
  v_and_b32 v173, 0xffff0000, v76
  v_pk_mul_f32 v[172:173], v[172:173], v[74:75]
  v_cvt_pk_bf16_f32 v186, v172, v173
  v_lshlrev_b32 v174, 16, v163
  v_and_b32 v175, 0xffff0000, v163
  v_pk_add_f32 v[174:175], v[174:175], v[72:73] neg_lo:[0,1] neg_hi:[0,1]
  v_cvt_pk_bf16_f32 v76, v174, v175
  v_lshlrev_b32 v174, 16, v76
  v_and_b32 v175, 0xffff0000, v76
  v_pk_mul_f32 v[174:175], v[174:175], v[74:75]
  v_cvt_pk_bf16_f32 v187, v174, v175
  v_lshlrev_b32 v176, 16, v164
  v_and_b32 v177, 0xffff0000, v164
  v_pk_add_f32 v[176:177], v[176:177], v[72:73] neg_lo:[0,1] neg_hi:[0,1]
  v_cvt_pk_bf16_f32 v76, v176, v177
  v_lshlrev_b32 v176, 16, v76
  v_and_b32 v177, 0xffff0000, v76
  v_pk_mul_f32 v[176:177], v[176:177], v[74:75]
  v_cvt_pk_bf16_f32 v188, v176, v177
  v_lshlrev_b32 v178, 16, v165
  v_and_b32 v179, 0xffff0000, v165
  v_pk_add_f32 v[178:179], v[178:179], v[72:73] neg_lo:[0,1] neg_hi:[0,1]
  v_cvt_pk_bf16_f32 v76, v178, v179
  v_lshlrev_b32 v178, 16, v76
  v_and_b32 v179, 0xffff0000, v76
  v_pk_mul_f32 v[178:179], v[178:179], v[74:75]
  v_cvt_pk_bf16_f32 v189, v178, v179
  v_lshlrev_b32 v180, 16, v166
  v_and_b32 v181, 0xffff0000, v166
  v_pk_add_f32 v[180:181], v[180:181], v[72:73] neg_lo:[0,1] neg_hi:[0,1]
  v_cvt_pk_bf16_f32 v76, v180, v181
  v_lshlrev_b32 v180, 16, v76
  v_and_b32 v181, 0xffff0000, v76
  v_pk_mul_f32 v[180:181], v[180:181], v[74:75]
  v_cvt_pk_bf16_f32 v190, v180, v181
  v_lshlrev_b32 v182, 16, v167
  v_and_b32 v183, 0xffff0000, v167
  v_pk_add_f32 v[182:183], v[182:183], v[72:73] neg_lo:[0,1] neg_hi:[0,1]
  v_cvt_pk_bf16_f32 v76, v182, v183
  v_lshlrev_b32 v182, 16, v76
  v_and_b32 v183, 0xffff0000, v76
  v_pk_mul_f32 v[182:183], v[182:183], v[74:75]
  v_cvt_pk_bf16_f32 v191, v182, v183
  s_lshl_b32 s52, s7, 3
  v_subrev_u32 v10, s52, v1
  v_cmp_gt_u32 vcc, 8, v10
  s_mul_i32 s53, s3, 272
  s_add_u32 s53, s53, 159744
  v_lshlrev_b32 v10, 5, v10
  v_add_u32 v10, s53, v10
  s_and_saveexec_b64 s[62:63], vcc
  ds_write_b128 v10, v[184:187]
  ds_write_b128 v10, v[188:191] offset:16
  s_mov_b64 exec, s[62:63]
  s_cmp_ge_u32 s3, 4
  s_cbranch_scc1 L_b1
  s_cmp_ge_u32 s3, 2
  s_cbranch_scc1 L_b1_ns
  s_waitcnt vmcnt(10)
  s_branch L_b1
L_b1_ns:
  s_waitcnt vmcnt(0)
L_b1:
  s_waitcnt lgkmcnt(0)
  s_cmp_lg_u32 s3, 0
  s_cbranch_scc1 L_noqf
  v_mov_b32 v10, 162272
  v_mov_b32 v11, 0
  ds_write_b32 v10, v11
  ds_write_b32 v10, v11 offset:48
  s_waitcnt lgkmcnt(0)
L_noqf:
  s_barrier
  s_add_u32 s66, s66, 1
  s_addc_u32 s67, s67, 0
  v_and_b32 v10, 1, v2
  v_cmp_eq_u32 vcc, 1, v10
  v_mov_b32 v11, 0xffff
  v_mov_b32 v12, 0xffff0000
  v_cndmask_b32 v11, v11, v12, vcc
  v_lshrrev_b32 v10, 1, v2
  v_cmp_eq_u32 vcc, 0, v10
  s_nop 1
  v_cndmask_b32 v16, 0, v11, vcc
  v_cmp_eq_u32 vcc, 1, v10
  s_nop 1
  v_cndmask_b32 v17, 0, v11, vcc
  v_cmp_eq_u32 vcc, 2, v10
  s_nop 1
  v_cndmask_b32 v18, 0, v11, vcc
  v_cmp_eq_u32 vcc, 3, v10
  s_nop 1
  v_cndmask_b32 v19, 0, v11, vcc
  v_mov_b32 v24, 0xff800000
  s_mov_b32 s68, 0x3db504f3
  s_mov_b32 s69, 0x3fb8aa3b
  v_mov_b32 v52, 0
  v_mov_b32 v53, 0
  v_mov_b32 v54, 0
  v_mov_b32 v55, 0
  s_cmp_ge_u32 s3, 4
  s_cbranch_scc1 L_high2
L_q_low:
  s_cmp_lt_u32 s3, 2
  s_cbranch_scc1 L_q_01
L_q_prod:
  v_and_b32 v10, 7, v1
  v_mul_u32_u24 v10, 272, v10
  v_lshlrev_b32 v11, 4, v3
  v_add_u32 v10, v10, v11
  v_add_u32 v10, 159744, v10
  ds_read_b128 v[160:163], v10 offset:0
  ds_read_b128 v[164:167], v10 offset:64
  ds_read_b128 v[168:171], v10 offset:128
  ds_read_b128 v[172:175], v10 offset:192
  v_lshlrev_b32 v11, 3, v3
  v_add_u32 v11, v11, v4
  v_lshlrev_b32 v11, 8, v11
  v_lshlrev_b32 v12, 3, v5
  v_add_u32 v11, v11, v12
  v_add_u32 v11, 126976, v11
  v_and_b32 v12, 1, v3
  v_lshlrev_b32 v12, 2, v12
  v_or_b32 v12, v12, v4
  s_sub_u32 s56, s3, 2
  s_lshl_b32 s52, s56, 2
  v_xor_b32 v12, s52, v12
  v_xor_b32 v13, 0, v12
  v_lshl_add_u32 v88, v13, 5, v11
  v_xor_b32 v13, 1, v12
  v_lshl_add_u32 v89, v13, 5, v11
  v_xor_b32 v13, 2, v12
  v_lshl_add_u32 v90, v13, 5, v11
  v_xor_b32 v13, 3, v12
  v_lshl_add_u32 v91, v13, 5, v11
  ds_read_b64_tr_b16 v[96:97], v88 offset:0
  ds_read_b64_tr_b16 v[98:99], v88 offset:1024
  ds_read_b64_tr_b16 v[100:101], v88 offset:8192
  ds_read_b64_tr_b16 v[102:103], v88 offset:9216
  ds_read_b64_tr_b16 v[104:105], v88 offset:16384
  ds_read_b64_tr_b16 v[106:107], v88 offset:17408
  ds_read_b64_tr_b16 v[108:109], v88 offset:24576
  ds_read_b64_tr_b16 v[110:111], v88 offset:25600
  ds_read_b64_tr_b16 v[112:113], v89 offset:0
  ds_read_b64_tr_b16 v[114:115], v89 offset:1024
  ds_read_b64_tr_b16 v[116:117], v89 offset:8192
  ds_read_b64_tr_b16 v[118:119], v89 offset:9216
  ds_read_b64_tr_b16 v[120:121], v89 offset:16384
  ds_read_b64_tr_b16 v[122:123], v89 offset:17408
  ds_read_b64_tr_b16 v[124:125], v89 offset:24576
  ds_read_b64_tr_b16 v[126:127], v89 offset:25600
  ds_read_b64_tr_b16 v[128:129], v90 offset:0
  ds_read_b64_tr_b16 v[130:131], v90 offset:1024
  ds_read_b64_tr_b16 v[132:133], v90 offset:8192
  ds_read_b64_tr_b16 v[134:135], v90 offset:9216
  ds_read_b64_tr_b16 v[136:137], v90 offset:16384
  ds_read_b64_tr_b16 v[138:139], v90 offset:17408
  ds_read_b64_tr_b16 v[140:141], v90 offset:24576
  ds_read_b64_tr_b16 v[142:143], v90 offset:25600
  ds_read_b64_tr_b16 v[144:145], v91 offset:0
  ds_read_b64_tr_b16 v[146:147], v91 offset:1024
  ds_read_b64_tr_b16 v[148:149], v91 offset:8192
  ds_read_b64_tr_b16 v[150:151], v91 offset:9216
  ds_read_b64_tr_b16 v[152:153], v91 offset:16384
  ds_read_b64_tr_b16 v[154:155], v91 offset:17408
  ds_read_b64_tr_b16 v[156:157], v91 offset:24576
  ds_read_b64_tr_b16 v[158:159], v91 offset:25600
  s_lshl_b32 s52, s6, 3
  s_add_u32 s52, s52, s7
  s_lshl_b32 s52, s52, 13
  s_lshl_b32 s53, s56, 9
  s_add_u32 s52, s52, s53
  s_add_u32 s52, s52, 5242880
  v_and_b32 v10, 7, v2
  v_lshlrev_b32 v10, 10, v10
  v_lshlrev_b32 v11, 5, v3
  v_lshrrev_b32 v12, 3, v2
  v_lshl_add_u32 v11, v12, 4, v11
  v_add3_u32 v26, v10, v11, s52
  v_cmp_eq_u32 s[60:61], 1, v12
  v_mov_b32 v178, s66
  v_mov_b32 v179, s67
  v_mov_b32 v182, s66
  v_mov_b32 v183, s67
  v_mov_b32 v186, s66
  v_mov_b32 v187, s67
  v_mov_b32 v190, s66
  v_mov_b32 v191, s67
  s_waitcnt lgkmcnt(0)
  v_mfma_f32_16x16x32_bf16 v[72:75], v[96:99], v[160:163], 0
  v_mfma_f32_16x16x32_bf16 v[76:79], v[112:115], v[160:163], 0
  v_mfma_f32_16x16x32_bf16 v[80:83], v[128:131], v[160:163], 0
  v_mfma_f32_16x16x32_bf16 v[84:87], v[144:147], v[160:163], 0
  v_mfma_f32_16x16x32_bf16 v[72:75], v[100:103], v[164:167], v[72:75]
  v_mfma_f32_16x16x32_bf16 v[76:79], v[116:119], v[164:167], v[76:79]
  v_mfma_f32_16x16x32_bf16 v[80:83], v[132:135], v[164:167], v[80:83]
  v_mfma_f32_16x16x32_bf16 v[84:87], v[148:151], v[164:167], v[84:87]
  v_mfma_f32_16x16x32_bf16 v[72:75], v[104:107], v[168:171], v[72:75]
  v_mfma_f32_16x16x32_bf16 v[76:79], v[120:123], v[168:171], v[76:79]
  v_mfma_f32_16x16x32_bf16 v[80:83], v[136:139], v[168:171], v[80:83]
  v_mfma_f32_16x16x32_bf16 v[84:87], v[152:155], v[168:171], v[84:87]
  v_mfma_f32_16x16x32_bf16 v[72:75], v[108:111], v[172:175], v[72:75]
  v_mfma_f32_16x16x32_bf16 v[76:79], v[124:127], v[172:175], v[76:79]
  v_mfma_f32_16x16x32_bf16 v[80:83], v[140:143], v[172:175], v[80:83]
  v_mfma_f32_16x16x32_bf16 v[84:87], v[156:159], v[172:175], v[84:87]
  s_nop 7
  v_cndmask_b32 v176, v72, v74, s[60:61]
  v_cndmask_b32 v177, v73, v75, s[60:61]
  v_cndmask_b32 v180, v76, v78, s[60:61]
  v_cndmask_b32 v181, v77, v79, s[60:61]
  v_cndmask_b32 v184, v80, v82, s[60:61]
  v_cndmask_b32 v185, v81, v83, s[60:61]
  v_cndmask_b32 v188, v84, v86, s[60:61]
  v_cndmask_b32 v189, v85, v87, s[60:61]
  global_store_dwordx4 v26, v[176:179], s[38:39] offset:0
  global_store_dwordx4 v26, v[180:183], s[38:39] offset:128
  global_store_dwordx4 v26, v[184:187], s[38:39] offset:256
  global_store_dwordx4 v26, v[188:191], s[38:39] offset:384
  s_branch L_prod2
L_q_w1:
  v_mov_b32 v10, 162272
  s_mov_b32 s50, 1048576
L_qf_wait:
  ds_read_b32 v11, v10
  s_waitcnt lgkmcnt(0)
  v_readfirstlane_b32 s52, v11
  s_nop 1
  s_cmp_lg_u32 s52, 0
  s_cbranch_scc1 L_q_ready
  s_sub_u32 s50, s50, 1
  s_cmp_lg_u32 s50, 0
  s_cbranch_scc1 L_qf_wait
  s_branch L_q_ready
L_q_w0:
  s_lshl_b32 s52, s6, 16
  s_lshl_b32 s53, s7, 10
  s_add_u32 s52, s52, s53
  s_add_u32 s52, s52, 5242880
  v_add_u32 v10, s52, v21
  v_add_u32 v80, 0, v10
  v_add_u32 v81, 8192, v10
  v_add_u32 v82, 16384, v10
  v_add_u32 v83, 24576, v10
  v_add_u32 v84, 32768, v10
  v_add_u32 v85, 40960, v10
  v_add_u32 v86, 49152, v10
  v_add_u32 v87, 57344, v10
  s_sleep 24
  s_mov_b32 s50, 1048576
L_qpoll_5:
  global_load_dwordx4 v[176:179], v80, s[38:39] sc1
  global_load_dwordx4 v[180:183], v81, s[38:39] sc1
  global_load_dwordx4 v[184:187], v82, s[38:39] sc1
  global_load_dwordx4 v[188:191], v83, s[38:39] sc1
  global_load_dwordx4 v[192:195], v84, s[38:39] sc1
  global_load_dwordx4 v[196:199], v85, s[38:39] sc1
  global_load_dwordx4 v[200:203], v86, s[38:39] sc1
  global_load_dwordx4 v[204:207], v87, s[38:39] sc1
  s_waitcnt vmcnt(0)
  v_mov_b32 v11, 0
  v_xor_b32 v12, s66, v178
  v_xor_b32 v13, s67, v179
  v_or3_b32 v11, v11, v12, v13
  v_xor_b32 v12, s66, v182
  v_xor_b32 v13, s67, v183
  v_or3_b32 v11, v11, v12, v13
  v_xor_b32 v12, s66, v186
  v_xor_b32 v13, s67, v187
  v_or3_b32 v11, v11, v12, v13
  v_xor_b32 v12, s66, v190
  v_xor_b32 v13, s67, v191
  v_or3_b32 v11, v11, v12, v13
  v_xor_b32 v12, s66, v194
  v_xor_b32 v13, s67, v195
  v_or3_b32 v11, v11, v12, v13
  v_xor_b32 v12, s66, v198
  v_xor_b32 v13, s67, v199
  v_or3_b32 v11, v11, v12, v13
  v_xor_b32 v12, s66, v202
  v_xor_b32 v13, s67, v203
  v_or3_b32 v11, v11, v12, v13
  v_xor_b32 v12, s66, v206
  v_xor_b32 v13, s67, v207
  v_or3_b32 v11, v11, v12, v13
  v_cmp_ne_u32 vcc, 0, v11
  s_cbranch_vccz L_qok_6
  s_sub_u32 s50, s50, 1
  s_cmp_lg_u32 s50, 0
  s_cbranch_scc1 L_qpoll_5
L_qok_6:
  v_add_f32 v176, v176, v180
  v_add_f32 v177, v177, v181
  v_add_f32 v176, v176, v184
  v_add_f32 v177, v177, v185
  v_add_f32 v176, v176, v188
  v_add_f32 v177, v177, v189
  v_add_f32 v176, v176, v192
  v_add_f32 v177, v177, v193
  v_add_f32 v176, v176, v196
  v_add_f32 v177, v177, v197
  v_add_f32 v176, v176, v200
  v_add_f32 v177, v177, v201
  v_add_f32 v176, v176, v204
  v_add_f32 v177, v177, v205
  v_cvt_pk_bf16_f32 v178, v176, v177
  v_lshlrev_b32 v11, 2, v1
  v_add_u32 v11, 161920, v11
  ds_write_b32 v11, v178
  s_waitcnt lgkmcnt(0)
  v_mov_b32 v10, 162272
  v_mov_b32 v11, 1
  ds_write_b32 v10, v11
L_q_ready:
  v_lshlrev_b32 v10, 2, v3
  v_add_u32 v10, v10, v5
  v_lshlrev_b32 v10, 4, v10
  v_add_u32 v10, 161920, v10
  ds_read_b128 v[72:75], v10
  s_lshl_b32 s52, s3, 6
  s_add_u32 s52, s52, 126976
  v_lshlrev_b32 v10, 4, v4
  v_lshlrev_b32 v11, 2, v3
  v_add3_u32 v22, v10, v11, s52
  s_waitcnt lgkmcnt(0)
  v_cmp_eq_u32 vcc, 0, v4
  s_nop 1
  v_cndmask_b32 v32, 0, v72, vcc
  v_cndmask_b32 v33, 0, v73, vcc
  v_cndmask_b32 v34, 0, v74, vcc
  v_cndmask_b32 v35, 0, v75, vcc
  v_cmp_eq_u32 vcc, 1, v4
  s_nop 1
  v_cndmask_b32 v36, 0, v72, vcc
  v_cndmask_b32 v37, 0, v73, vcc
  v_cndmask_b32 v38, 0, v74, vcc
  v_cndmask_b32 v39, 0, v75, vcc
  v_cmp_eq_u32 vcc, 2, v4
  s_nop 1
  v_cndmask_b32 v40, 0, v72, vcc
  v_cndmask_b32 v41, 0, v73, vcc
  v_cndmask_b32 v42, 0, v74, vcc
  v_cndmask_b32 v43, 0, v75, vcc
  v_cmp_eq_u32 vcc, 3, v4
  s_nop 1
  v_cndmask_b32 v44, 0, v72, vcc
  v_cndmask_b32 v45, 0, v73, vcc
  v_cndmask_b32 v46, 0, v74, vcc
  v_cndmask_b32 v47, 0, v75, vcc
  s_mov_b32 s15, 25
  .p2align 6
L_kloop:
  s_waitcnt vmcnt(9)
  s_nop 0
  v_mfma_f32_16x16x32_bf16 v[48:51], v[32:35], v[96:99], 0
  buffer_load_dwordx4 v[96:99], v20, s[40:43], s48 offen offset:2048 nt
  s_waitcnt vmcnt(9)
  s_nop 0
  v_mfma_f32_16x16x32_bf16 v[48:51], v[36:39], v[100:103], v[48:51]
  buffer_load_dwordx4 v[100:103], v20, s[40:43], s48 offen offset:3072 nt
  s_add_u32 s48, s48, 8192
  s_waitcnt vmcnt(9)
  s_nop 0
  v_mfma_f32_16x16x32_bf16 v[48:51], v[40:43], v[104:107], v[48:51]
  buffer_load_dwordx4 v[104:107], v20, s[40:43], s48 offen offset:0 nt
  s_waitcnt vmcnt(9)
  s_nop 0
  v_mfma_f32_16x16x32_bf16 v[48:51], v[44:47], v[108:111], v[48:51]
  buffer_load_dwordx4 v[108:111], v20, s[40:43], s48 offen offset:1024 nt
  s_nop 7
  v_mov_b32_dpp v72, v48 quad_perm:[0,0,0,0] row_mask:0xf bank_mask:0xf
  v_add_f32_dpp v72, v49, v72 quad_perm:[1,1,1,1] row_mask:0xf bank_mask:0xf
  v_add_f32_dpp v72, v50, v72 quad_perm:[2,2,2,2] row_mask:0xf bank_mask:0xf
  v_add_f32_dpp v72, v51, v72 quad_perm:[3,3,3,3] row_mask:0xf bank_mask:0xf
  v_cvt_pk_bf16_f32 v72, v72, v72
  v_and_b32 v72, 0xffff0000, v72
  v_mul_f32 v72, s68, v72
  v_cvt_pk_bf16_f32 v72, v72, v72
  v_and_b32 v72, 0xffff0000, v72
  v_max_f32 v24, v24, v72
  ds_write_b32 v22, v72 offset:0
  s_waitcnt vmcnt(9)
  s_nop 0
  v_mfma_f32_16x16x32_bf16 v[48:51], v[32:35], v[112:115], 0
  buffer_load_dwordx4 v[112:115], v20, s[40:43], s48 offen offset:2048 nt
  s_waitcnt vmcnt(9)
  s_nop 0
  v_mfma_f32_16x16x32_bf16 v[48:51], v[36:39], v[116:119], v[48:51]
  buffer_load_dwordx4 v[116:119], v20, s[40:43], s48 offen offset:3072 nt
  s_add_u32 s48, s48, 8192
  s_waitcnt vmcnt(9)
  s_nop 0
  v_mfma_f32_16x16x32_bf16 v[48:51], v[40:43], v[120:123], v[48:51]
  buffer_load_dwordx4 v[120:123], v20, s[40:43], s48 offen offset:0 nt
  s_waitcnt vmcnt(9)
  s_nop 0
  v_mfma_f32_16x16x32_bf16 v[48:51], v[44:47], v[124:127], v[48:51]
  buffer_load_dwordx4 v[124:127], v20, s[40:43], s48 offen offset:1024 nt
  s_nop 7
  v_mov_b32_dpp v72, v48 quad_perm:[0,0,0,0] row_mask:0xf bank_mask:0xf
  v_add_f32_dpp v72, v49, v72 quad_perm:[1,1,1,1] row_mask:0xf bank_mask:0xf
  v_add_f32_dpp v72, v50, v72 quad_perm:[2,2,2,2] row_mask:0xf bank_mask:0xf
  v_add_f32_dpp v72, v51, v72 quad_perm:[3,3,3,3] row_mask:0xf bank_mask:0xf
  v_cvt_pk_bf16_f32 v72, v72, v72
  v_and_b32 v72, 0xffff0000, v72
  v_mul_f32 v72, s68, v72
  v_cvt_pk_bf16_f32 v72, v72, v72
  v_and_b32 v72, 0xffff0000, v72
  v_max_f32 v24, v24, v72
  ds_write_b32 v22, v72 offset:128
  s_waitcnt vmcnt(9)
  s_nop 0
  v_mfma_f32_16x16x32_bf16 v[48:51], v[32:35], v[128:131], 0
  buffer_load_dwordx4 v[128:131], v20, s[40:43], s48 offen offset:2048 nt
  s_waitcnt vmcnt(9)
  s_nop 0
  v_mfma_f32_16x16x32_bf16 v[48:51], v[36:39], v[132:135], v[48:51]
  buffer_load_dwordx4 v[132:135], v20, s[40:43], s48 offen offset:3072 nt
  s_add_u32 s48, s48, 8192
  s_waitcnt vmcnt(9)
  s_nop 0
  v_mfma_f32_16x16x32_bf16 v[48:51], v[40:43], v[96:99], v[48:51]
  buffer_load_dwordx4 v[96:99], v20, s[40:43], s48 offen offset:0 nt
  s_waitcnt vmcnt(9)
  s_nop 0
  v_mfma_f32_16x16x32_bf16 v[48:51], v[44:47], v[100:103], v[48:51]
  buffer_load_dwordx4 v[100:103], v20, s[40:43], s48 offen offset:1024 nt
  s_nop 7
  v_mov_b32_dpp v72, v48 quad_perm:[0,0,0,0] row_mask:0xf bank_mask:0xf
  v_add_f32_dpp v72, v49, v72 quad_perm:[1,1,1,1] row_mask:0xf bank_mask:0xf
  v_add_f32_dpp v72, v50, v72 quad_perm:[2,2,2,2] row_mask:0xf bank_mask:0xf
  v_add_f32_dpp v72, v51, v72 quad_perm:[3,3,3,3] row_mask:0xf bank_mask:0xf
  v_cvt_pk_bf16_f32 v72, v72, v72
  v_and_b32 v72, 0xffff0000, v72
  v_mul_f32 v72, s68, v72
  v_cvt_pk_bf16_f32 v72, v72, v72
  v_and_b32 v72, 0xffff0000, v72
  v_max_f32 v24, v24, v72
  ds_write_b32 v22, v72 offset:256
  s_waitcnt vmcnt(9)
  s_nop 0
  v_mfma_f32_16x16x32_bf16 v[48:51], v[32:35], v[104:107], 0
  buffer_load_dwordx4 v[104:107], v20, s[40:43], s48 offen offset:2048 nt
  s_waitcnt vmcnt(9)
  s_nop 0
  v_mfma_f32_16x16x32_bf16 v[48:51], v[36:39], v[108:111], v[48:51]
  buffer_load_dwordx4 v[108:111], v20, s[40:43], s48 offen offset:3072 nt
  s_add_u32 s48, s48, 8192
  s_waitcnt vmcnt(9)
  s_nop 0
  v_mfma_f32_16x16x32_bf16 v[48:51], v[40:43], v[112:115], v[48:51]
  buffer_load_dwordx4 v[112:115], v20, s[40:43], s48 offen offset:0 nt
  s_waitcnt vmcnt(9)
  s_nop 0
  v_mfma_f32_16x16x32_bf16 v[48:51], v[44:47], v[116:119], v[48:51]
  buffer_load_dwordx4 v[116:119], v20, s[40:43], s48 offen offset:1024 nt
  s_nop 7
  v_mov_b32_dpp v72, v48 quad_perm:[0,0,0,0] row_mask:0xf bank_mask:0xf
  v_add_f32_dpp v72, v49, v72 quad_perm:[1,1,1,1] row_mask:0xf bank_mask:0xf
  v_add_f32_dpp v72, v50, v72 quad_perm:[2,2,2,2] row_mask:0xf bank_mask:0xf
  v_add_f32_dpp v72, v51, v72 quad_perm:[3,3,3,3] row_mask:0xf bank_mask:0xf
  v_cvt_pk_bf16_f32 v72, v72, v72
  v_and_b32 v72, 0xffff0000, v72
  v_mul_f32 v72, s68, v72
  v_cvt_pk_bf16_f32 v72, v72, v72
  v_and_b32 v72, 0xffff0000, v72
  v_max_f32 v24, v24, v72
  ds_write_b32 v22, v72 offset:384
  s_waitcnt vmcnt(9)
  s_nop 0
  v_mfma_f32_16x16x32_bf16 v[48:51], v[32:35], v[120:123], 0
  buffer_load_dwordx4 v[120:123], v20, s[40:43], s48 offen offset:2048 nt
  s_waitcnt vmcnt(9)
  s_nop 0
  v_mfma_f32_16x16x32_bf16 v[48:51], v[36:39], v[124:127], v[48:51]
  buffer_load_dwordx4 v[124:127], v20, s[40:43], s48 offen offset:3072 nt
  s_add_u32 s48, s48, 8192
  s_waitcnt vmcnt(9)
  s_nop 0
  v_mfma_f32_16x16x32_bf16 v[48:51], v[40:43], v[128:131], v[48:51]
  buffer_load_dwordx4 v[128:131], v20, s[40:43], s48 offen offset:0 nt
  s_waitcnt vmcnt(9)
  s_nop 0
  v_mfma_f32_16x16x32_bf16 v[48:51], v[44:47], v[132:135], v[48:51]
  buffer_load_dwordx4 v[132:135], v20, s[40:43], s48 offen offset:1024 nt
  s_nop 7
  v_mov_b32_dpp v72, v48 quad_perm:[0,0,0,0] row_mask:0xf bank_mask:0xf
  v_add_f32_dpp v72, v49, v72 quad_perm:[1,1,1,1] row_mask:0xf bank_mask:0xf
  v_add_f32_dpp v72, v50, v72 quad_perm:[2,2,2,2] row_mask:0xf bank_mask:0xf
  v_add_f32_dpp v72, v51, v72 quad_perm:[3,3,3,3] row_mask:0xf bank_mask:0xf
  v_cvt_pk_bf16_f32 v72, v72, v72
  v_and_b32 v72, 0xffff0000, v72
  v_mul_f32 v72, s68, v72
  v_cvt_pk_bf16_f32 v72, v72, v72
  v_and_b32 v72, 0xffff0000, v72
  v_max_f32 v24, v24, v72
  ds_write_b32 v22, v72 offset:512
  v_add_u32 v22, 640, v22
  s_sub_u32 s15, s15, 1
  s_cmp_lg_u32 s15, 0
  s_cbranch_scc1 L_kloop
  s_waitcnt vmcnt(9)
  s_nop 0
  v_mfma_f32_16x16x32_bf16 v[48:51], v[32:35], v[96:99], 0
  buffer_load_dwordx4 v[96:99], v20, s[40:43], s48 offen offset:2048 nt
  s_waitcnt vmcnt(9)
  s_nop 0
  v_mfma_f32_16x16x32_bf16 v[48:51], v[36:39], v[100:103], v[48:51]
  buffer_load_dwordx4 v[100:103], v20, s[40:43], s48 offen offset:3072 nt
  s_add_u32 s48, s48, 8192
  s_waitcnt vmcnt(9)
  s_nop 0
  v_mfma_f32_16x16x32_bf16 v[48:51], v[40:43], v[104:107], v[48:51]
  s_add_u32 s48, s3, 6
  s_lshl_b32 s48, s48, 12
  buffer_load_dwordx4 v[104:107], v21, s[44:47], s48 offen offset:0 nt
  s_waitcnt vmcnt(9)
  s_nop 0
  v_mfma_f32_16x16x32_bf16 v[48:51], v[44:47], v[108:111], v[48:51]
  buffer_load_dwordx4 v[108:111], v21, s[44:47], s48 offen offset:1024 nt
  s_nop 7
  v_mov_b32_dpp v72, v48 quad_perm:[0,0,0,0] row_mask:0xf bank_mask:0xf
  v_add_f32_dpp v72, v49, v72 quad_perm:[1,1,1,1] row_mask:0xf bank_mask:0xf
  v_add_f32_dpp v72, v50, v72 quad_perm:[2,2,2,2] row_mask:0xf bank_mask:0xf
  v_add_f32_dpp v72, v51, v72 quad_perm:[3,3,3,3] row_mask:0xf bank_mask:0xf
  v_cvt_pk_bf16_f32 v72, v72, v72
  v_and_b32 v72, 0xffff0000, v72
  v_mul_f32 v72, s68, v72
  v_cvt_pk_bf16_f32 v72, v72, v72
  v_and_b32 v72, 0xffff0000, v72
  v_max_f32 v24, v24, v72
  ds_write_b32 v22, v72 offset:0
  s_waitcnt vmcnt(9)
  s_nop 0
  v_mfma_f32_16x16x32_bf16 v[48:51], v[32:35], v[112:115], 0
  buffer_load_dwordx4 v[112:115], v21, s[44:47], s48 offen offset:2048 nt
  s_waitcnt vmcnt(9)
  s_nop 0
  v_mfma_f32_16x16x32_bf16 v[48:51], v[36:39], v[116:119], v[48:51]
  buffer_load_dwordx4 v[116:119], v21, s[44:47], s48 offen offset:3072 nt
  s_add_u32 s48, s48, 8192
  s_waitcnt vmcnt(9)
  s_nop 0
  v_mfma_f32_16x16x32_bf16 v[48:51], v[40:43], v[120:123], v[48:51]
  buffer_load_dwordx4 v[120:123], v21, s[44:47], s48 offen offset:0 nt
  s_waitcnt vmcnt(9)
  s_nop 0
  v_mfma_f32_16x16x32_bf16 v[48:51], v[44:47], v[124:127], v[48:51]
  buffer_load_dwordx4 v[124:127], v21, s[44:47], s48 offen offset:1024 nt
  s_nop 7
  v_mov_b32_dpp v72, v48 quad_perm:[0,0,0,0] row_mask:0xf bank_mask:0xf
  v_add_f32_dpp v72, v49, v72 quad_perm:[1,1,1,1] row_mask:0xf bank_mask:0xf
  v_add_f32_dpp v72, v50, v72 quad_perm:[2,2,2,2] row_mask:0xf bank_mask:0xf
  v_add_f32_dpp v72, v51, v72 quad_perm:[3,3,3,3] row_mask:0xf bank_mask:0xf
  v_cvt_pk_bf16_f32 v72, v72, v72
  v_and_b32 v72, 0xffff0000, v72
  v_mul_f32 v72, s68, v72
  v_cvt_pk_bf16_f32 v72, v72, v72
  v_and_b32 v72, 0xffff0000, v72
  v_max_f32 v24, v24, v72
  ds_write_b32 v22, v72 offset:128
  s_waitcnt vmcnt(9)
  s_nop 0
  v_mfma_f32_16x16x32_bf16 v[48:51], v[32:35], v[128:131], 0
  buffer_load_dwordx4 v[128:131], v21, s[44:47], s48 offen offset:2048 nt
  s_waitcnt vmcnt(9)
  s_nop 0
  v_mfma_f32_16x16x32_bf16 v[48:51], v[36:39], v[132:135], v[48:51]
  buffer_load_dwordx4 v[132:135], v21, s[44:47], s48 offen offset:3072 nt
  s_add_u32 s48, s48, 8192
  s_waitcnt vmcnt(9)
  s_nop 0
  v_mfma_f32_16x16x32_bf16 v[48:51], v[40:43], v[96:99], v[48:51]
  buffer_load_dwordx4 v[96:99], v21, s[44:47], s48 offen offset:0 nt
  s_waitcnt vmcnt(9)
  s_nop 0
  v_mfma_f32_16x16x32_bf16 v[48:51], v[44:47], v[100:103], v[48:51]
  buffer_load_dwordx4 v[100:103], v21, s[44:47], s48 offen offset:1024 nt
  s_nop 7
  v_mov_b32_dpp v72, v48 quad_perm:[0,0,0,0] row_mask:0xf bank_mask:0xf
  v_add_f32_dpp v72, v49, v72 quad_perm:[1,1,1,1] row_mask:0xf bank_mask:0xf
  v_add_f32_dpp v72, v50, v72 quad_perm:[2,2,2,2] row_mask:0xf bank_mask:0xf
  v_add_f32_dpp v72, v51, v72 quad_perm:[3,3,3,3] row_mask:0xf bank_mask:0xf
  v_cvt_pk_bf16_f32 v72, v72, v72
  v_and_b32 v72, 0xffff0000, v72
  v_mul_f32 v72, s68, v72
  v_cvt_pk_bf16_f32 v72, v72, v72
  v_and_b32 v72, 0xffff0000, v72
  v_max_f32 v24, v24, v72
  ds_write_b32 v22, v72 offset:256
L_kdone:
  s_nop 1
  v_max_f32_dpp v24, v24, v24 row_ror:8 row_mask:0xf bank_mask:0xf
  s_nop 1
  v_max_f32_dpp v24, v24, v24 row_ror:4 row_mask:0xf bank_mask:0xf
  s_nop 1
  v_max_f32_dpp v24, v24, v24 row_ror:2 row_mask:0xf bank_mask:0xf
  s_nop 1
  v_max_f32_dpp v24, v24, v24 row_ror:1 row_mask:0xf bank_mask:0xf
  s_nop 1
  v_readlane_b32 s52, v24, 0
  v_readlane_b32 s53, v24, 16
  v_readlane_b32 s54, v24, 32
  v_readlane_b32 s55, v24, 48
  s_nop 1
  v_mov_b32 v24, s52
  v_max_f32 v24, s53, v24
  v_max_f32 v24, s54, v24
  v_max_f32 v24, s55, v24
  s_lshl_b32 s52, s3, 2
  s_add_u32 s52, s52, 162176
  v_mov_b32 v11, s52
  ds_write_b32 v11, v24
  s_waitcnt lgkmcnt(0)
  s_barrier
  s_cmp_lg_u32 s3, 2
  s_cbranch_scc1 L_nokd
  v_mov_b32 v12, 162320
  ds_read_b32 v13, v12
  s_lshl_b32 s52, s4, 9
  s_add_u32 s52, s52, 81920
  v_and_b32 v10, 31, v1
  v_lshlrev_b32 v10, 4, v10
  v_add_u32 v10, s52, v10
  global_load_dwordx4 v[248:251], v10, s[38:39] sc1
  s_lshl_b32 s53, s5, 4
  s_add_u32 s52, s52, s53
  v_mov_b32 v10, s52
  v_mov_b32 v168, 1
  v_mov_b32 v169, 0
  v_mov_b32 v170, s66
  v_mov_b32 v171, s67
  s_waitcnt lgkmcnt(0)
  v_readfirstlane_b32 s49, v13
  s_nop 1
  s_sub_u32 s49, s49, 1
  s_mov_b32 exec_lo, 1
  s_mov_b32 exec_hi, 0
  s_cmp_eq_u32 s49, 0
  s_cbranch_scc1 L_st_slow_7
  global_store_dwordx4 v10, v[168:171], s[38:39]
  s_branch L_st_done_8
L_st_slow_7:
  global_store_dwordx4 v10, v[168:171], s[38:39] sc1
L_st_done_8:
  s_mov_b64 exec, -1
  v_mov_b32 v10, 162352
  v_mov_b32 v11, 0
  ds_write_b32 v10, v11
L_nokd:
  s_cmp_lt_u32 s3, 2
  s_cbranch_scc1 L_nohv
  s_sub_u32 s52, s3, 2
  s_mul_i32 s52, s52, 4096
  buffer_load_dwordx4 v[96:99], v21, s[44:47], s52 offen offset:0 nt
  buffer_load_dwordx4 v[100:103], v21, s[44:47], s52 offen offset:1024 nt
  buffer_load_dwordx4 v[104:107], v21, s[44:47], s52 offen offset:2048 nt
  buffer_load_dwordx4 v[108:111], v21, s[44:47], s52 offen offset:3072 nt
L_nohv:
  v_mov_b32 v12, 162320
  ds_read_b32 v13, v12
  v_mov_b32 v11, 162176
  ds_read_b128 v[160:163], v11
  ds_read_b128 v[164:167], v11 offset:16
  s_lshl_b32 s56, s3, 11
  s_add_u32 s56, s56, 126976
  v_lshlrev_b32 v10, 5, v1
  v_add_u32 v10, s56, v10
  ds_read_b128 v[72:75], v10
  ds_read_b128 v[76:79], v10 offset:16
  s_waitcnt lgkmcnt(2)
  v_readfirstlane_b32 s49, v13
  v_max3_f32 v24, v160, v161, v162
  s_sub_u32 s49, s49, 1
  v_max3_f32 v24, v24, v163, v164
  v_max3_f32 v24, v24, v165, v166
  v_max_f32 v24, v24, v167
  s_waitcnt lgkmcnt(0)
  v_sub_f32 v80, v72, v24
  v_mul_f32 v80, s69, v80
  v_exp_f32 v80, v80
  v_sub_f32 v81, v73, v24
  v_mul_f32 v81, s69, v81
  v_exp_f32 v81, v81
  v_sub_f32 v82, v74, v24
  v_mul_f32 v82, s69, v82
  v_exp_f32 v82, v82
  v_sub_f32 v83, v75, v24
  v_mul_f32 v83, s69, v83
  v_exp_f32 v83, v83
  v_sub_f32 v84, v76, v24
  v_mul_f32 v84, s69, v84
  v_exp_f32 v84, v84
  v_sub_f32 v85, v77, v24
  v_mul_f32 v85, s69, v85
  v_exp_f32 v85, v85
  v_sub_f32 v86, v78, v24
  v_mul_f32 v86, s69, v86
  v_exp_f32 v86, v86
  v_sub_f32 v87, v79, v24
  v_mul_f32 v87, s69, v87
  v_exp_f32 v87, v87
  s_nop 0
  v_add_f32 v88, v80, v81
  v_add_f32 v88, v88, v82
  v_add_f32 v88, v88, v83
  v_add_f32 v88, v88, v84
  v_add_f32 v88, v88, v85
  v_add_f32 v88, v88, v86
  v_add_f32 v88, v88, v87
  s_nop 1
  v_add_f32_dpp v88, v88, v88 row_ror:8 row_mask:0xf bank_mask:0xf
  s_nop 1
  v_add_f32_dpp v88, v88, v88 row_ror:4 row_mask:0xf bank_mask:0xf
  s_nop 1
  v_add_f32_dpp v88, v88, v88 row_ror:2 row_mask:0xf bank_mask:0xf
  s_nop 1
  v_add_f32_dpp v88, v88, v88 row_ror:1 row_mask:0xf bank_mask:0xf
  s_nop 1
  v_readlane_b32 s52, v88, 0
  v_readlane_b32 s53, v88, 16
  v_readlane_b32 s54, v88, 32
  v_readlane_b32 s55, v88, 48
  s_nop 1
  v_mov_b32 v88, s52
  v_add_f32 v88, s53, v88
  v_add_f32 v88, s54, v88
  v_add_f32 v88, s55, v88
  s_lshl_b32 s52, s3, 2
  s_add_u32 s52, s52, 162288
  v_mov_b32 v11, s52
  ds_write_b32 v11, v88
  s_waitcnt lgkmcnt(0)
  s_barrier
  v_mov_b32 v11, 162288
  ds_read_b128 v[160:163], v11
  ds_read_b128 v[164:167], v11 offset:16
  s_waitcnt lgkmcnt(0)
  v_add_f32 v88, v160, v161
  v_add_f32 v88, v88, v162
  v_add_f32 v88, v88, v163
  v_add_f32 v88, v88, v164
  v_add_f32 v88, v88, v165
  v_add_f32 v88, v88, v166
  v_add_f32 v88, v88, v167
  v_rcp_f32 v89, v88
  s_nop 0
  v_fma_f32 v90, -v88, v89, 1.0
  v_fma_f32 v89, v90, v89, v89
  v_mul_f32 v80, v80, v89
  v_cvt_pk_bf16_f32 v80, v80, v80
  v_mul_f32 v81, v81, v89
  v_cvt_pk_bf16_f32 v81, v81, v81
  v_mul_f32 v82, v82, v89
  v_cvt_pk_bf16_f32 v82, v82, v82
  v_mul_f32 v83, v83, v89
  v_cvt_pk_bf16_f32 v83, v83, v83
  v_mul_f32 v84, v84, v89
  v_cvt_pk_bf16_f32 v84, v84, v84
  v_mul_f32 v85, v85, v89
  v_cvt_pk_bf16_f32 v85, v85, v85
  v_mul_f32 v86, v86, v89
  v_cvt_pk_bf16_f32 v86, v86, v86
  v_mul_f32 v87, v87, v89
  v_cvt_pk_bf16_f32 v87, v87, v87
  ds_write_b128 v10, v[80:83]
  ds_write_b128 v10, v[84:87] offset:16
  s_waitcnt lgkmcnt(0)
  s_barrier
  s_cmp_lt_u32 s3, 2
  s_cbranch_scc1 L_vstream
  s_cmp_lg_u32 s3, 2
  s_cbranch_scc1 L_nokd2
  s_waitcnt vmcnt(5)
  v_xor_b32 v11, s66, v250
  v_xor_b32 v15, s67, v251
  v_or_b32 v11, v11, v15
  v_cmp_eq_u32 vcc, 0, v11
  s_nop 1
  s_bcnt1_i32_b32 s52, vcc_lo
  s_cmp_ge_u32 s52, 20
  s_cselect_b32 s52, 1, 0
  v_mov_b32 v11, 162352
  v_mov_b32 v15, s52
  ds_write_b32 v11, v15
L_nokd2:
  s_sub_u32 s52, s3, 2
  s_mul_i32 s52, s52, 64
  s_add_u32 s52, s52, 126976
  v_lshlrev_b32 v10, 4, v3
  v_add_u32 v10, s52, v10
  ds_read_b128 v[64:67], v10 offset:0
  s_waitcnt vmcnt(0) lgkmcnt(0)
  v_and_b32 v56, v64, v16
  v_and_b32 v57, v64, v17
  v_and_b32 v58, v64, v18
  v_and_b32 v59, v64, v19
  s_nop 1
  v_mfma_f32_16x16x32_bf16 v[52:55], v[56:59], v[96:99], v[52:55]
  v_and_b32 v60, v65, v16
  v_and_b32 v61, v65, v17
  v_and_b32 v62, v65, v18
  v_and_b32 v63, v65, v19
  s_nop 1
  v_mfma_f32_16x16x32_bf16 v[52:55], v[60:63], v[100:103], v[52:55]
  v_and_b32 v56, v66, v16
  v_and_b32 v57, v66, v17
  v_and_b32 v58, v66, v18
  v_and_b32 v59, v66, v19
  s_nop 1
  v_mfma_f32_16x16x32_bf16 v[52:55], v[56:59], v[104:107], v[52:55]
  v_and_b32 v60, v67, v16
  v_and_b32 v61, v67, v17
  v_and_b32 v62, v67, v18
  v_and_b32 v63, v67, v19
  s_nop 1
  v_mfma_f32_16x16x32_bf16 v[52:55], v[60:63], v[108:111], v[52:55]
  s_nop 7
  s_mov_b32 exec_lo, -1
  s_mov_b32 exec_hi, 0
  ds_write_b128 v227, v[52:55]
  s_mov_b64 exec, -1
  s_lshl_b32 s52, s3, 12
  s_add_u32 s53, s52, 0
  v_add_u32 v13, s53, v229
  ds_read_b64_tr_b16 v[96:97], v13 offset:0
  ds_read_b64_tr_b16 v[98:99], v13 offset:512
  ds_read_b64_tr_b16 v[100:101], v13 offset:32
  ds_read_b64_tr_b16 v[102:103], v13 offset:544
  ds_read_b64_tr_b16 v[104:105], v13 offset:64
  ds_read_b64_tr_b16 v[106:107], v13 offset:576
  ds_read_b64_tr_b16 v[108:109], v13 offset:96
  ds_read_b64_tr_b16 v[110:111], v13 offset:608
  s_lshr_b32 s52, s3, 2
  s_lshl_b32 s52, s52, 15
  s_and_b32 s53, s3, 3
  s_lshl_b32 s53, s53, 5
  s_add_u32 s52, s52, s53
  s_add_u32 s52, s52, 32768
  v_add_u32 v15, s52, v229
  ds_read_b64_tr_b16 v[112:113], v15 offset:0
  ds_read_b64_tr_b16 v[114:115], v15 offset:512
  ds_read_b64_tr_b16 v[116:117], v15 offset:4096
  ds_read_b64_tr_b16 v[118:119], v15 offset:4608
  ds_read_b64_tr_b16 v[120:121], v15 offset:8192
  ds_read_b64_tr_b16 v[122:123], v15 offset:8704
  ds_read_b64_tr_b16 v[124:125], v15 offset:12288
  ds_read_b64_tr_b16 v[126:127], v15 offset:12800
  ds_read_b64_tr_b16 v[128:129], v15 offset:16384
  ds_read_b64_tr_b16 v[130:131], v15 offset:16896
  ds_read_b64_tr_b16 v[132:133], v15 offset:20480
  ds_read_b64_tr_b16 v[134:135], v15 offset:20992
  ds_read_b64_tr_b16 v[136:137], v15 offset:24576
  ds_read_b64_tr_b16 v[138:139], v15 offset:25088
  ds_read_b64_tr_b16 v[140:141], v15 offset:28672
  ds_read_b64_tr_b16 v[142:143], v15 offset:29184
  s_lshl_b32 s52, s3, 12
  s_add_u32 s53, s52, 98304
  v_add_u32 v11, s53, v229
  ds_read_b64_tr_b16 v[144:145], v11 offset:0
  ds_read_b64_tr_b16 v[146:147], v11 offset:512
  ds_read_b64_tr_b16 v[148:149], v11 offset:32
  ds_read_b64_tr_b16 v[150:151], v11 offset:544
  ds_read_b64_tr_b16 v[152:153], v11 offset:64
  ds_read_b64_tr_b16 v[154:155], v11 offset:576
  ds_read_b64_tr_b16 v[156:157], v11 offset:96
  ds_read_b64_tr_b16 v[158:159], v11 offset:608
  s_cmp_lg_u32 s3, 4
  s_cbranch_scc1 L_pf2_skip
  s_getpc_b64 s[60:61]
L_pf2:
  s_add_u32 s60, s60, (L_vdone-L_pf2)&0xffffffff
  s_addc_u32 s61, s61, (L_vdone-L_pf2)>>32
  v_lshlrev_b32 v10, 6, v1
  s_mov_b32 s52, L_exit-L_vdone
L_pf2_loop:
  v_cmp_gt_u32 vcc, s52, v10
  s_and_saveexec_b64 s[62:63], vcc
  s_cbranch_execz L_pf2_done
  global_load_dword v11, v10, s[60:61]
  s_mov_b64 exec, s[62:63]
  v_add_u32 v10, 4096, v10
  s_branch L_pf2_loop
L_pf2_done:
  s_mov_b64 exec, s[62:63]
  s_waitcnt vmcnt(0)
L_pf2_skip:
  s_waitcnt vmcnt(0) lgkmcnt(0)
  s_branch L_vdone
L_vstream:
  s_add_u32 s52, s3, 6
  s_lshl_b32 s52, s52, 6
  s_add_u32 s52, s52, 126976
  v_lshlrev_b32 v10, 4, v3
  v_add_u32 v23, s52, v10
  ds_read_b128 v[64:67], v23
  ds_read_b128 v[68:71], v23 offset:128
  s_waitcnt lgkmcnt(1)
  s_nop 0
  v_and_b32 v56, v64, v16
  v_and_b32 v57, v64, v17
  v_and_b32 v58, v64, v18
  v_and_b32 v59, v64, v19
  s_waitcnt vmcnt(9)
  s_nop 0
  v_mfma_f32_16x16x32_bf16 v[52:55], v[56:59], v[104:107], v[52:55]
  buffer_load_dwordx4 v[104:107], v21, s[44:47], s48 offen offset:2048 nt
  v_and_b32 v60, v65, v16
  v_and_b32 v61, v65, v17
  v_and_b32 v62, v65, v18
  v_and_b32 v63, v65, v19
  s_waitcnt vmcnt(9)
  s_nop 0
  v_mfma_f32_16x16x32_bf16 v[52:55], v[60:63], v[108:111], v[52:55]
  buffer_load_dwordx4 v[108:111], v21, s[44:47], s48 offen offset:3072 nt
  s_add_u32 s48, s48, 8192
  v_and_b32 v56, v66, v16
  v_and_b32 v57, v66, v17
  v_and_b32 v58, v66, v18
  v_and_b32 v59, v66, v19
  s_waitcnt vmcnt(9)
  s_nop 0
  v_mfma_f32_16x16x32_bf16 v[52:55], v[56:59], v[112:115], v[52:55]
  buffer_load_dwordx4 v[112:115], v21, s[44:47], s48 offen offset:0 nt
  v_and_b32 v60, v67, v16
  v_and_b32 v61, v67, v17
  v_and_b32 v62, v67, v18
  v_and_b32 v63, v67, v19
  s_waitcnt vmcnt(9)
  s_nop 0
  v_mfma_f32_16x16x32_bf16 v[52:55], v[60:63], v[116:119], v[52:55]
  buffer_load_dwordx4 v[116:119], v21, s[44:47], s48 offen offset:1024 nt
  ds_read_b128 v[64:67], v23 offset:256
  s_waitcnt lgkmcnt(1)
  s_nop 0
  v_and_b32 v56, v68, v16
  v_and_b32 v57, v68, v17
  v_and_b32 v58, v68, v18
  v_and_b32 v59, v68, v19
  s_waitcnt vmcnt(9)
  s_nop 0
  v_mfma_f32_16x16x32_bf16 v[52:55], v[56:59], v[120:123], v[52:55]
  buffer_load_dwordx4 v[120:123], v21, s[44:47], s48 offen offset:2048 nt
  v_and_b32 v60, v69, v16
  v_and_b32 v61, v69, v17
  v_and_b32 v62, v69, v18
  v_and_b32 v63, v69, v19
  s_waitcnt vmcnt(9)
  s_nop 0
  v_mfma_f32_16x16x32_bf16 v[52:55], v[60:63], v[124:127], v[52:55]
  buffer_load_dwordx4 v[124:127], v21, s[44:47], s48 offen offset:3072 nt
  s_add_u32 s48, s48, 8192
  v_and_b32 v56, v70, v16
  v_and_b32 v57, v70, v17
  v_and_b32 v58, v70, v18
  v_and_b32 v59, v70, v19
  s_waitcnt vmcnt(9)
  s_nop 0
  v_mfma_f32_16x16x32_bf16 v[52:55], v[56:59], v[128:131], v[52:55]
  buffer_load_dwordx4 v[128:131], v21, s[44:47], s48 offen offset:0 nt
  v_and_b32 v60, v71, v16
  v_and_b32 v61, v71, v17
  v_and_b32 v62, v71, v18
  v_and_b32 v63, v71, v19
  s_waitcnt vmcnt(9)
  s_nop 0
  v_mfma_f32_16x16x32_bf16 v[52:55], v[60:63], v[132:135], v[52:55]
  buffer_load_dwordx4 v[132:135], v21, s[44:47], s48 offen offset:1024 nt
  ds_read_b128 v[68:71], v23 offset:384
  s_waitcnt lgkmcnt(1)
  s_nop 0
  v_and_b32 v56, v64, v16
  v_and_b32 v57, v64, v17
  v_and_b32 v58, v64, v18
  v_and_b32 v59, v64, v19
  s_waitcnt vmcnt(9)
  s_nop 0
  v_mfma_f32_16x16x32_bf16 v[52:55], v[56:59], v[96:99], v[52:55]
  buffer_load_dwordx4 v[96:99], v21, s[44:47], s48 offen offset:2048 nt
  v_and_b32 v60, v65, v16
  v_and_b32 v61, v65, v17
  v_and_b32 v62, v65, v18
  v_and_b32 v63, v65, v19
  s_waitcnt vmcnt(9)
  s_nop 0
  v_mfma_f32_16x16x32_bf16 v[52:55], v[60:63], v[100:103], v[52:55]
  buffer_load_dwordx4 v[100:103], v21, s[44:47], s48 offen offset:3072 nt
  s_add_u32 s48, s48, 8192
  v_and_b32 v56, v66, v16
  v_and_b32 v57, v66, v17
  v_and_b32 v58, v66, v18
  v_and_b32 v59, v66, v19
  s_waitcnt vmcnt(9)
  s_nop 0
  v_mfma_f32_16x16x32_bf16 v[52:55], v[56:59], v[104:107], v[52:55]
  buffer_load_dwordx4 v[104:107], v21, s[44:47], s48 offen offset:0 nt
  v_and_b32 v60, v67, v16
  v_and_b32 v61, v67, v17
  v_and_b32 v62, v67, v18
  v_and_b32 v63, v67, v19
  s_waitcnt vmcnt(9)
  s_nop 0
  v_mfma_f32_16x16x32_bf16 v[52:55], v[60:63], v[108:111], v[52:55]
  buffer_load_dwordx4 v[108:111], v21, s[44:47], s48 offen offset:1024 nt
  ds_read_b128 v[64:67], v23 offset:512
  s_waitcnt lgkmcnt(1)
  s_nop 0
  v_and_b32 v56, v68, v16
  v_and_b32 v57, v68, v17
  v_and_b32 v58, v68, v18
  v_and_b32 v59, v68, v19
  s_waitcnt vmcnt(9)
  s_nop 0
  v_mfma_f32_16x16x32_bf16 v[52:55], v[56:59], v[112:115], v[52:55]
  buffer_load_dwordx4 v[112:115], v21, s[44:47], s48 offen offset:2048 nt
  v_and_b32 v60, v69, v16
  v_and_b32 v61, v69, v17
  v_and_b32 v62, v69, v18
  v_and_b32 v63, v69, v19
  s_waitcnt vmcnt(9)
  s_nop 0
  v_mfma_f32_16x16x32_bf16 v[52:55], v[60:63], v[116:119], v[52:55]
  buffer_load_dwordx4 v[116:119], v21, s[44:47], s48 offen offset:3072 nt
  s_add_u32 s48, s48, 8192
  v_and_b32 v56, v70, v16
  v_and_b32 v57, v70, v17
  v_and_b32 v58, v70, v18
  v_and_b32 v59, v70, v19
  s_waitcnt vmcnt(9)
  s_nop 0
  v_mfma_f32_16x16x32_bf16 v[52:55], v[56:59], v[120:123], v[52:55]
  buffer_load_dwordx4 v[120:123], v21, s[44:47], s48 offen offset:0 nt
  v_and_b32 v60, v71, v16
  v_and_b32 v61, v71, v17
  v_and_b32 v62, v71, v18
  v_and_b32 v63, v71, v19
  s_waitcnt vmcnt(9)
  s_nop 0
  v_mfma_f32_16x16x32_bf16 v[52:55], v[60:63], v[124:127], v[52:55]
  buffer_load_dwordx4 v[124:127], v21, s[44:47], s48 offen offset:1024 nt
  ds_read_b128 v[68:71], v23 offset:640
  s_waitcnt lgkmcnt(1)
  s_nop 0
  v_and_b32 v56, v64, v16
  v_and_b32 v57, v64, v17
  v_and_b32 v58, v64, v18
  v_and_b32 v59, v64, v19
  s_waitcnt vmcnt(9)
  s_nop 0
  v_mfma_f32_16x16x32_bf16 v[52:55], v[56:59], v[128:131], v[52:55]
  buffer_load_dwordx4 v[128:131], v21, s[44:47], s48 offen offset:2048 nt
  v_and_b32 v60, v65, v16
  v_and_b32 v61, v65, v17
  v_and_b32 v62, v65, v18
  v_and_b32 v63, v65, v19
  s_waitcnt vmcnt(9)
  s_nop 0
  v_mfma_f32_16x16x32_bf16 v[52:55], v[60:63], v[132:135], v[52:55]
  buffer_load_dwordx4 v[132:135], v21, s[44:47], s48 offen offset:3072 nt
  s_add_u32 s48, s48, 8192
  v_and_b32 v56, v66, v16
  v_and_b32 v57, v66, v17
  v_and_b32 v58, v66, v18
  v_and_b32 v59, v66, v19
  s_waitcnt vmcnt(9)
  s_nop 0
  v_mfma_f32_16x16x32_bf16 v[52:55], v[56:59], v[96:99], v[52:55]
  buffer_load_dwordx4 v[96:99], v21, s[44:47], s48 offen offset:0 nt
  v_and_b32 v60, v67, v16
  v_and_b32 v61, v67, v17
  v_and_b32 v62, v67, v18
  v_and_b32 v63, v67, v19
  s_waitcnt vmcnt(9)
  s_nop 0
  v_mfma_f32_16x16x32_bf16 v[52:55], v[60:63], v[100:103], v[52:55]
  buffer_load_dwordx4 v[100:103], v21, s[44:47], s48 offen offset:1024 nt
  ds_read_b128 v[64:67], v23 offset:768
  s_waitcnt lgkmcnt(1)
  s_nop 0
  v_and_b32 v56, v68, v16
  v_and_b32 v57, v68, v17
  v_and_b32 v58, v68, v18
  v_and_b32 v59, v68, v19
  s_waitcnt vmcnt(9)
  s_nop 0
  v_mfma_f32_16x16x32_bf16 v[52:55], v[56:59], v[104:107], v[52:55]
  buffer_load_dwordx4 v[104:107], v21, s[44:47], s48 offen offset:2048 nt
  v_and_b32 v60, v69, v16
  v_and_b32 v61, v69, v17
  v_and_b32 v62, v69, v18
  v_and_b32 v63, v69, v19
  s_waitcnt vmcnt(9)
  s_nop 0
  v_mfma_f32_16x16x32_bf16 v[52:55], v[60:63], v[108:111], v[52:55]
  buffer_load_dwordx4 v[108:111], v21, s[44:47], s48 offen offset:3072 nt
  s_add_u32 s48, s48, 8192
  v_and_b32 v56, v70, v16
  v_and_b32 v57, v70, v17
  v_and_b32 v58, v70, v18
  v_and_b32 v59, v70, v19
  s_waitcnt vmcnt(9)
  s_nop 0
  v_mfma_f32_16x16x32_bf16 v[52:55], v[56:59], v[112:115], v[52:55]
  buffer_load_dwordx4 v[112:115], v21, s[44:47], s48 offen offset:0 nt
  v_and_b32 v60, v71, v16
  v_and_b32 v61, v71, v17
  v_and_b32 v62, v71, v18
  v_and_b32 v63, v71, v19
  s_waitcnt vmcnt(9)
  s_nop 0
  v_mfma_f32_16x16x32_bf16 v[52:55], v[60:63], v[116:119], v[52:55]
  buffer_load_dwordx4 v[116:119], v21, s[44:47], s48 offen offset:1024 nt
  ds_read_b128 v[68:71], v23 offset:896
  s_waitcnt lgkmcnt(1)
  s_nop 0
  v_and_b32 v56, v64, v16
  v_and_b32 v57, v64, v17
  v_and_b32 v58, v64, v18
  v_and_b32 v59, v64, v19
  s_waitcnt vmcnt(9)
  s_nop 0
  v_mfma_f32_16x16x32_bf16 v[52:55], v[56:59], v[120:123], v[52:55]
  buffer_load_dwordx4 v[120:123], v21, s[44:47], s48 offen offset:2048 nt
  v_and_b32 v60, v65, v16
  v_and_b32 v61, v65, v17
  v_and_b32 v62, v65, v18
  v_and_b32 v63, v65, v19
  s_waitcnt vmcnt(9)
  s_nop 0
  v_mfma_f32_16x16x32_bf16 v[52:55], v[60:63], v[124:127], v[52:55]
  buffer_load_dwordx4 v[124:127], v21, s[44:47], s48 offen offset:3072 nt
  s_add_u32 s48, s48, 8192
  v_and_b32 v56, v66, v16
  v_and_b32 v57, v66, v17
  v_and_b32 v58, v66, v18
  v_and_b32 v59, v66, v19
  s_waitcnt vmcnt(9)
  s_nop 0
  v_mfma_f32_16x16x32_bf16 v[52:55], v[56:59], v[128:131], v[52:55]
  buffer_load_dwordx4 v[128:131], v21, s[44:47], s48 offen offset:0 nt
  v_and_b32 v60, v67, v16
  v_and_b32 v61, v67, v17
  v_and_b32 v62, v67, v18
  v_and_b32 v63, v67, v19
  s_waitcnt vmcnt(9)
  s_nop 0
  v_mfma_f32_16x16x32_bf16 v[52:55], v[60:63], v[132:135], v[52:55]
  buffer_load_dwordx4 v[132:135], v21, s[44:47], s48 offen offset:1024 nt
  ds_read_b128 v[64:67], v23 offset:1024
  s_waitcnt lgkmcnt(1)
  s_nop 0
  v_and_b32 v56, v68, v16
  v_and_b32 v57, v68, v17
  v_and_b32 v58, v68, v18
  v_and_b32 v59, v68, v19
  s_waitcnt vmcnt(9)
  s_nop 0
  v_mfma_f32_16x16x32_bf16 v[52:55], v[56:59], v[96:99], v[52:55]
  buffer_load_dwordx4 v[96:99], v21, s[44:47], s48 offen offset:2048 nt
  v_and_b32 v60, v69, v16
  v_and_b32 v61, v69, v17
  v_and_b32 v62, v69, v18
  v_and_b32 v63, v69, v19
  s_waitcnt vmcnt(9)
  s_nop 0
  v_mfma_f32_16x16x32_bf16 v[52:55], v[60:63], v[100:103], v[52:55]
  buffer_load_dwordx4 v[100:103], v21, s[44:47], s48 offen offset:3072 nt
  s_add_u32 s48, s48, 8192
  v_and_b32 v56, v70, v16
  v_and_b32 v57, v70, v17
  v_and_b32 v58, v70, v18
  v_and_b32 v59, v70, v19
  s_waitcnt vmcnt(9)
  s_nop 0
  v_mfma_f32_16x16x32_bf16 v[52:55], v[56:59], v[104:107], v[52:55]
  buffer_load_dwordx4 v[104:107], v21, s[44:47], s48 offen offset:0 nt
  v_and_b32 v60, v71, v16
  v_and_b32 v61, v71, v17
  v_and_b32 v62, v71, v18
  v_and_b32 v63, v71, v19
  s_waitcnt vmcnt(9)
  s_nop 0
  v_mfma_f32_16x16x32_bf16 v[52:55], v[60:63], v[108:111], v[52:55]
  buffer_load_dwordx4 v[108:111], v21, s[44:47], s48 offen offset:1024 nt
  ds_read_b128 v[68:71], v23 offset:1152
  s_waitcnt lgkmcnt(1)
  s_nop 0
  v_and_b32 v56, v64, v16
  v_and_b32 v57, v64, v17
  v_and_b32 v58, v64, v18
  v_and_b32 v59, v64, v19
  s_waitcnt vmcnt(9)
  s_nop 0
  v_mfma_f32_16x16x32_bf16 v[52:55], v[56:59], v[112:115], v[52:55]
  buffer_load_dwordx4 v[112:115], v21, s[44:47], s48 offen offset:2048 nt
  v_and_b32 v60, v65, v16
  v_and_b32 v61, v65, v17
  v_and_b32 v62, v65, v18
  v_and_b32 v63, v65, v19
  s_waitcnt vmcnt(9)
  s_nop 0
  v_mfma_f32_16x16x32_bf16 v[52:55], v[60:63], v[116:119], v[52:55]
  buffer_load_dwordx4 v[116:119], v21, s[44:47], s48 offen offset:3072 nt
  s_add_u32 s48, s48, 8192
  v_and_b32 v56, v66, v16
  v_and_b32 v57, v66, v17
  v_and_b32 v58, v66, v18
  v_and_b32 v59, v66, v19
  s_waitcnt vmcnt(9)
  s_nop 0
  v_mfma_f32_16x16x32_bf16 v[52:55], v[56:59], v[120:123], v[52:55]
  buffer_load_dwordx4 v[120:123], v21, s[44:47], s48 offen offset:0 nt
  v_and_b32 v60, v67, v16
  v_and_b32 v61, v67, v17
  v_and_b32 v62, v67, v18
  v_and_b32 v63, v67, v19
  s_waitcnt vmcnt(9)
  s_nop 0
  v_mfma_f32_16x16x32_bf16 v[52:55], v[60:63], v[124:127], v[52:55]
  buffer_load_dwordx4 v[124:127], v21, s[44:47], s48 offen offset:1024 nt
  ds_read_b128 v[64:67], v23 offset:1280
  s_waitcnt lgkmcnt(1)
  s_nop 0
  v_and_b32 v56, v68, v16
  v_and_b32 v57, v68, v17
  v_and_b32 v58, v68, v18
  v_and_b32 v59, v68, v19
  s_waitcnt vmcnt(9)
  s_nop 0
  v_mfma_f32_16x16x32_bf16 v[52:55], v[56:59], v[128:131], v[52:55]
  buffer_load_dwordx4 v[128:131], v21, s[44:47], s48 offen offset:2048 nt
  v_and_b32 v60, v69, v16
  v_and_b32 v61, v69, v17
  v_and_b32 v62, v69, v18
  v_and_b32 v63, v69, v19
  s_waitcnt vmcnt(9)
  s_nop 0
  v_mfma_f32_16x16x32_bf16 v[52:55], v[60:63], v[132:135], v[52:55]
  buffer_load_dwordx4 v[132:135], v21, s[44:47], s48 offen offset:3072 nt
  s_add_u32 s48, s48, 8192
  v_and_b32 v56, v70, v16
  v_and_b32 v57, v70, v17
  v_and_b32 v58, v70, v18
  v_and_b32 v59, v70, v19
  s_waitcnt vmcnt(9)
  s_nop 0
  v_mfma_f32_16x16x32_bf16 v[52:55], v[56:59], v[96:99], v[52:55]
  buffer_load_dwordx4 v[96:99], v21, s[44:47], s48 offen offset:0 nt
  v_and_b32 v60, v71, v16
  v_and_b32 v61, v71, v17
  v_and_b32 v62, v71, v18
  v_and_b32 v63, v71, v19
  s_waitcnt vmcnt(9)
  s_nop 0
  v_mfma_f32_16x16x32_bf16 v[52:55], v[60:63], v[100:103], v[52:55]
  buffer_load_dwordx4 v[100:103], v21, s[44:47], s48 offen offset:1024 nt
  v_add_u32 v23, 1280, v23
  v_mov_b32 v10, 162352
  ds_read_b32 v11, v10
  s_waitcnt lgkmcnt(0)
  v_readfirstlane_b32 s52, v11
  s_nop 1
  s_cmp_eq_u32 s52, 1
  s_cbranch_scc1 L_vlate
  s_mov_b32 s15, 11
  .p2align 6
L_vloop:
  ds_read_b128 v[68:71], v23 offset:128
  s_waitcnt lgkmcnt(1)
  s_nop 0
  v_and_b32 v56, v64, v16
  v_and_b32 v57, v64, v17
  v_and_b32 v58, v64, v18
  v_and_b32 v59, v64, v19
  s_waitcnt vmcnt(9)
  s_nop 0
  v_mfma_f32_16x16x32_bf16 v[52:55], v[56:59], v[104:107], v[52:55]
  buffer_load_dwordx4 v[104:107], v21, s[44:47], s48 offen offset:2048 nt
  v_and_b32 v60, v65, v16
  v_and_b32 v61, v65, v17
  v_and_b32 v62, v65, v18
  v_and_b32 v63, v65, v19
  s_waitcnt vmcnt(9)
  s_nop 0
  v_mfma_f32_16x16x32_bf16 v[52:55], v[60:63], v[108:111], v[52:55]
  buffer_load_dwordx4 v[108:111], v21, s[44:47], s48 offen offset:3072 nt
  s_add_u32 s48, s48, 8192
  v_and_b32 v56, v66, v16
  v_and_b32 v57, v66, v17
  v_and_b32 v58, v66, v18
  v_and_b32 v59, v66, v19
  s_waitcnt vmcnt(9)
  s_nop 0
  v_mfma_f32_16x16x32_bf16 v[52:55], v[56:59], v[112:115], v[52:55]
  buffer_load_dwordx4 v[112:115], v21, s[44:47], s48 offen offset:0 nt
  v_and_b32 v60, v67, v16
  v_and_b32 v61, v67, v17
  v_and_b32 v62, v67, v18
  v_and_b32 v63, v67, v19
  s_waitcnt vmcnt(9)
  s_nop 0
  v_mfma_f32_16x16x32_bf16 v[52:55], v[60:63], v[116:119], v[52:55]
  buffer_load_dwordx4 v[116:119], v21, s[44:47], s48 offen offset:1024 nt
  ds_read_b128 v[64:67], v23 offset:256
  s_waitcnt lgkmcnt(1)
  s_nop 0
  v_and_b32 v56, v68, v16
  v_and_b32 v57, v68, v17
  v_and_b32 v58, v68, v18
  v_and_b32 v59, v68, v19
  s_waitcnt vmcnt(9)
  s_nop 0
  v_mfma_f32_16x16x32_bf16 v[52:55], v[56:59], v[120:123], v[52:55]
  buffer_load_dwordx4 v[120:123], v21, s[44:47], s48 offen offset:2048 nt
  v_and_b32 v60, v69, v16
  v_and_b32 v61, v69, v17
  v_and_b32 v62, v69, v18
  v_and_b32 v63, v69, v19
  s_waitcnt vmcnt(9)
  s_nop 0
  v_mfma_f32_16x16x32_bf16 v[52:55], v[60:63], v[124:127], v[52:55]
  buffer_load_dwordx4 v[124:127], v21, s[44:47], s48 offen offset:3072 nt
  s_add_u32 s48, s48, 8192
  v_and_b32 v56, v70, v16
  v_and_b32 v57, v70, v17
  v_and_b32 v58, v70, v18
  v_and_b32 v59, v70, v19
  s_waitcnt vmcnt(9)
  s_nop 0
  v_mfma_f32_16x16x32_bf16 v[52:55], v[56:59], v[128:131], v[52:55]
  buffer_load_dwordx4 v[128:131], v21, s[44:47], s48 offen offset:0 nt
  v_and_b32 v60, v71, v16
  v_and_b32 v61, v71, v17
  v_and_b32 v62, v71, v18
  v_and_b32 v63, v71, v19
  s_waitcnt vmcnt(9)
  s_nop 0
  v_mfma_f32_16x16x32_bf16 v[52:55], v[60:63], v[132:135], v[52:55]
  buffer_load_dwordx4 v[132:135], v21, s[44:47], s48 offen offset:1024 nt
  ds_read_b128 v[68:71], v23 offset:384
  s_waitcnt lgkmcnt(1)
  s_nop 0
  v_and_b32 v56, v64, v16
  v_and_b32 v57, v64, v17
  v_and_b32 v58, v64, v18
  v_and_b32 v59, v64, v19
  s_waitcnt vmcnt(9)
  s_nop 0
  v_mfma_f32_16x16x32_bf16 v[52:55], v[56:59], v[96:99], v[52:55]
  buffer_load_dwordx4 v[96:99], v21, s[44:47], s48 offen offset:2048 nt
  v_and_b32 v60, v65, v16
  v_and_b32 v61, v65, v17
  v_and_b32 v62, v65, v18
  v_and_b32 v63, v65, v19
  s_waitcnt vmcnt(9)
  s_nop 0
  v_mfma_f32_16x16x32_bf16 v[52:55], v[60:63], v[100:103], v[52:55]
  buffer_load_dwordx4 v[100:103], v21, s[44:47], s48 offen offset:3072 nt
  s_add_u32 s48, s48, 8192
  v_and_b32 v56, v66, v16
  v_and_b32 v57, v66, v17
  v_and_b32 v58, v66, v18
  v_and_b32 v59, v66, v19
  s_waitcnt vmcnt(9)
  s_nop 0
  v_mfma_f32_16x16x32_bf16 v[52:55], v[56:59], v[104:107], v[52:55]
  buffer_load_dwordx4 v[104:107], v21, s[44:47], s48 offen offset:0 nt
  v_and_b32 v60, v67, v16
  v_and_b32 v61, v67, v17
  v_and_b32 v62, v67, v18
  v_and_b32 v63, v67, v19
  s_waitcnt vmcnt(9)
  s_nop 0
  v_mfma_f32_16x16x32_bf16 v[52:55], v[60:63], v[108:111], v[52:55]
  buffer_load_dwordx4 v[108:111], v21, s[44:47], s48 offen offset:1024 nt
  ds_read_b128 v[64:67], v23 offset:512
  s_waitcnt lgkmcnt(1)
  s_nop 0
  v_and_b32 v56, v68, v16
  v_and_b32 v57, v68, v17
  v_and_b32 v58, v68, v18
  v_and_b32 v59, v68, v19
  s_waitcnt vmcnt(9)
  s_nop 0
  v_mfma_f32_16x16x32_bf16 v[52:55], v[56:59], v[112:115], v[52:55]
  buffer_load_dwordx4 v[112:115], v21, s[44:47], s48 offen offset:2048 nt
  v_and_b32 v60, v69, v16
  v_and_b32 v61, v69, v17
  v_and_b32 v62, v69, v18
  v_and_b32 v63, v69, v19
  s_waitcnt vmcnt(9)
  s_nop 0
  v_mfma_f32_16x16x32_bf16 v[52:55], v[60:63], v[116:119], v[52:55]
  buffer_load_dwordx4 v[116:119], v21, s[44:47], s48 offen offset:3072 nt
  s_add_u32 s48, s48, 8192
  v_and_b32 v56, v70, v16
  v_and_b32 v57, v70, v17
  v_and_b32 v58, v70, v18
  v_and_b32 v59, v70, v19
  s_waitcnt vmcnt(9)
  s_nop 0
  v_mfma_f32_16x16x32_bf16 v[52:55], v[56:59], v[120:123], v[52:55]
  buffer_load_dwordx4 v[120:123], v21, s[44:47], s48 offen offset:0 nt
  v_and_b32 v60, v71, v16
  v_and_b32 v61, v71, v17
  v_and_b32 v62, v71, v18
  v_and_b32 v63, v71, v19
  s_waitcnt vmcnt(9)
  s_nop 0
  v_mfma_f32_16x16x32_bf16 v[52:55], v[60:63], v[124:127], v[52:55]
  buffer_load_dwordx4 v[124:127], v21, s[44:47], s48 offen offset:1024 nt
  ds_read_b128 v[68:71], v23 offset:640
  s_waitcnt lgkmcnt(1)
  s_nop 0
  v_and_b32 v56, v64, v16
  v_and_b32 v57, v64, v17
  v_and_b32 v58, v64, v18
  v_and_b32 v59, v64, v19
  s_waitcnt vmcnt(9)
  s_nop 0
  v_mfma_f32_16x16x32_bf16 v[52:55], v[56:59], v[128:131], v[52:55]
  buffer_load_dwordx4 v[128:131], v21, s[44:47], s48 offen offset:2048 nt
  v_and_b32 v60, v65, v16
  v_and_b32 v61, v65, v17
  v_and_b32 v62, v65, v18
  v_and_b32 v63, v65, v19
  s_waitcnt vmcnt(9)
  s_nop 0
  v_mfma_f32_16x16x32_bf16 v[52:55], v[60:63], v[132:135], v[52:55]
  buffer_load_dwordx4 v[132:135], v21, s[44:47], s48 offen offset:3072 nt
  s_add_u32 s48, s48, 8192
  v_and_b32 v56, v66, v16
  v_and_b32 v57, v66, v17
  v_and_b32 v58, v66, v18
  v_and_b32 v59, v66, v19
  s_waitcnt vmcnt(9)
  s_nop 0
  v_mfma_f32_16x16x32_bf16 v[52:55], v[56:59], v[96:99], v[52:55]
  buffer_load_dwordx4 v[96:99], v21, s[44:47], s48 offen offset:0 nt
  v_and_b32 v60, v67, v16
  v_and_b32 v61, v67, v17
  v_and_b32 v62, v67, v18
  v_and_b32 v63, v67, v19
  s_waitcnt vmcnt(9)
  s_nop 0
  v_mfma_f32_16x16x32_bf16 v[52:55], v[60:63], v[100:103], v[52:55]
  buffer_load_dwordx4 v[100:103], v21, s[44:47], s48 offen offset:1024 nt
  ds_read_b128 v[64:67], v23 offset:768
  s_waitcnt lgkmcnt(1)
  s_nop 0
  v_and_b32 v56, v68, v16
  v_and_b32 v57, v68, v17
  v_and_b32 v58, v68, v18
  v_and_b32 v59, v68, v19
  s_waitcnt vmcnt(9)
  s_nop 0
  v_mfma_f32_16x16x32_bf16 v[52:55], v[56:59], v[104:107], v[52:55]
  buffer_load_dwordx4 v[104:107], v21, s[44:47], s48 offen offset:2048 nt
  v_and_b32 v60, v69, v16
  v_and_b32 v61, v69, v17
  v_and_b32 v62, v69, v18
  v_and_b32 v63, v69, v19
  s_waitcnt vmcnt(9)
  s_nop 0
  v_mfma_f32_16x16x32_bf16 v[52:55], v[60:63], v[108:111], v[52:55]
  buffer_load_dwordx4 v[108:111], v21, s[44:47], s48 offen offset:3072 nt
  s_add_u32 s48, s48, 8192
  v_and_b32 v56, v70, v16
  v_and_b32 v57, v70, v17
  v_and_b32 v58, v70, v18
  v_and_b32 v59, v70, v19
  s_waitcnt vmcnt(9)
  s_nop 0
  v_mfma_f32_16x16x32_bf16 v[52:55], v[56:59], v[112:115], v[52:55]
  buffer_load_dwordx4 v[112:115], v21, s[44:47], s48 offen offset:0 nt
  v_and_b32 v60, v71, v16
  v_and_b32 v61, v71, v17
  v_and_b32 v62, v71, v18
  v_and_b32 v63, v71, v19
  s_waitcnt vmcnt(9)
  s_nop 0
  v_mfma_f32_16x16x32_bf16 v[52:55], v[60:63], v[116:119], v[52:55]
  buffer_load_dwordx4 v[116:119], v21, s[44:47], s48 offen offset:1024 nt
  ds_read_b128 v[68:71], v23 offset:896
  s_waitcnt lgkmcnt(1)
  s_nop 0
  v_and_b32 v56, v64, v16
  v_and_b32 v57, v64, v17
  v_and_b32 v58, v64, v18
  v_and_b32 v59, v64, v19
  s_waitcnt vmcnt(9)
  s_nop 0
  v_mfma_f32_16x16x32_bf16 v[52:55], v[56:59], v[120:123], v[52:55]
  buffer_load_dwordx4 v[120:123], v21, s[44:47], s48 offen offset:2048 nt
  v_and_b32 v60, v65, v16
  v_and_b32 v61, v65, v17
  v_and_b32 v62, v65, v18
  v_and_b32 v63, v65, v19
  s_waitcnt vmcnt(9)
  s_nop 0
  v_mfma_f32_16x16x32_bf16 v[52:55], v[60:63], v[124:127], v[52:55]
  buffer_load_dwordx4 v[124:127], v21, s[44:47], s48 offen offset:3072 nt
  s_add_u32 s48, s48, 8192
  v_and_b32 v56, v66, v16
  v_and_b32 v57, v66, v17
  v_and_b32 v58, v66, v18
  v_and_b32 v59, v66, v19
  s_waitcnt vmcnt(9)
  s_nop 0
  v_mfma_f32_16x16x32_bf16 v[52:55], v[56:59], v[128:131], v[52:55]
  buffer_load_dwordx4 v[128:131], v21, s[44:47], s48 offen offset:0 nt
  v_and_b32 v60, v67, v16
  v_and_b32 v61, v67, v17
  v_and_b32 v62, v67, v18
  v_and_b32 v63, v67, v19
  s_waitcnt vmcnt(9)
  s_nop 0
  v_mfma_f32_16x16x32_bf16 v[52:55], v[60:63], v[132:135], v[52:55]
  buffer_load_dwordx4 v[132:135], v21, s[44:47], s48 offen offset:1024 nt
  ds_read_b128 v[64:67], v23 offset:1024
  s_waitcnt lgkmcnt(1)
  s_nop 0
  v_and_b32 v56, v68, v16
  v_and_b32 v57, v68, v17
  v_and_b32 v58, v68, v18
  v_and_b32 v59, v68, v19
  s_waitcnt vmcnt(9)
  s_nop 0
  v_mfma_f32_16x16x32_bf16 v[52:55], v[56:59], v[96:99], v[52:55]
  buffer_load_dwordx4 v[96:99], v21, s[44:47], s48 offen offset:2048 nt
  v_and_b32 v60, v69, v16
  v_and_b32 v61, v69, v17
  v_and_b32 v62, v69, v18
  v_and_b32 v63, v69, v19
  s_waitcnt vmcnt(9)
  s_nop 0
  v_mfma_f32_16x16x32_bf16 v[52:55], v[60:63], v[100:103], v[52:55]
  buffer_load_dwordx4 v[100:103], v21, s[44:47], s48 offen offset:3072 nt
  s_add_u32 s48, s48, 8192
  v_and_b32 v56, v70, v16
  v_and_b32 v57, v70, v17
  v_and_b32 v58, v70, v18
  v_and_b32 v59, v70, v19
  s_waitcnt vmcnt(9)
  s_nop 0
  v_mfma_f32_16x16x32_bf16 v[52:55], v[56:59], v[104:107], v[52:55]
  buffer_load_dwordx4 v[104:107], v21, s[44:47], s48 offen offset:0 nt
  v_and_b32 v60, v71, v16
  v_and_b32 v61, v71, v17
  v_and_b32 v62, v71, v18
  v_and_b32 v63, v71, v19
  s_waitcnt vmcnt(9)
  s_nop 0
  v_mfma_f32_16x16x32_bf16 v[52:55], v[60:63], v[108:111], v[52:55]
  buffer_load_dwordx4 v[108:111], v21, s[44:47], s48 offen offset:1024 nt
  ds_read_b128 v[68:71], v23 offset:1152
  s_waitcnt lgkmcnt(1)
  s_nop 0
  v_and_b32 v56, v64, v16
  v_and_b32 v57, v64, v17
  v_and_b32 v58, v64, v18
  v_and_b32 v59, v64, v19
  s_waitcnt vmcnt(9)
  s_nop 0
  v_mfma_f32_16x16x32_bf16 v[52:55], v[56:59], v[112:115], v[52:55]
  buffer_load_dwordx4 v[112:115], v21, s[44:47], s48 offen offset:2048 nt
  v_and_b32 v60, v65, v16
  v_and_b32 v61, v65, v17
  v_and_b32 v62, v65, v18
  v_and_b32 v63, v65, v19
  s_waitcnt vmcnt(9)
  s_nop 0
  v_mfma_f32_16x16x32_bf16 v[52:55], v[60:63], v[116:119], v[52:55]
  buffer_load_dwordx4 v[116:119], v21, s[44:47], s48 offen offset:3072 nt
  s_add_u32 s48, s48, 8192
  v_and_b32 v56, v66, v16
  v_and_b32 v57, v66, v17
  v_and_b32 v58, v66, v18
  v_and_b32 v59, v66, v19
  s_waitcnt vmcnt(9)
  s_nop 0
  v_mfma_f32_16x16x32_bf16 v[52:55], v[56:59], v[120:123], v[52:55]
  buffer_load_dwordx4 v[120:123], v21, s[44:47], s48 offen offset:0 nt
  v_and_b32 v60, v67, v16
  v_and_b32 v61, v67, v17
  v_and_b32 v62, v67, v18
  v_and_b32 v63, v67, v19
  s_waitcnt vmcnt(9)
  s_nop 0
  v_mfma_f32_16x16x32_bf16 v[52:55], v[60:63], v[124:127], v[52:55]
  buffer_load_dwordx4 v[124:127], v21, s[44:47], s48 offen offset:1024 nt
  ds_read_b128 v[64:67], v23 offset:1280
  s_waitcnt lgkmcnt(1)
  s_nop 0
  v_and_b32 v56, v68, v16
  v_and_b32 v57, v68, v17
  v_and_b32 v58, v68, v18
  v_and_b32 v59, v68, v19
  s_waitcnt vmcnt(9)
  s_nop 0
  v_mfma_f32_16x16x32_bf16 v[52:55], v[56:59], v[128:131], v[52:55]
  buffer_load_dwordx4 v[128:131], v21, s[44:47], s48 offen offset:2048 nt
  v_and_b32 v60, v69, v16
  v_and_b32 v61, v69, v17
  v_and_b32 v62, v69, v18
  v_and_b32 v63, v69, v19
  s_waitcnt vmcnt(9)
  s_nop 0
  v_mfma_f32_16x16x32_bf16 v[52:55], v[60:63], v[132:135], v[52:55]
  buffer_load_dwordx4 v[132:135], v21, s[44:47], s48 offen offset:3072 nt
  s_add_u32 s48, s48, 8192
  v_and_b32 v56, v70, v16
  v_and_b32 v57, v70, v17
  v_and_b32 v58, v70, v18
  v_and_b32 v59, v70, v19
  s_waitcnt vmcnt(9)
  s_nop 0
  v_mfma_f32_16x16x32_bf16 v[52:55], v[56:59], v[96:99], v[52:55]
  buffer_load_dwordx4 v[96:99], v21, s[44:47], s48 offen offset:0 nt
  v_and_b32 v60, v71, v16
  v_and_b32 v61, v71, v17
  v_and_b32 v62, v71, v18
  v_and_b32 v63, v71, v19
  s_waitcnt vmcnt(9)
  s_nop 0
  v_mfma_f32_16x16x32_bf16 v[52:55], v[60:63], v[100:103], v[52:55]
  buffer_load_dwordx4 v[100:103], v21, s[44:47], s48 offen offset:1024 nt
  v_add_u32 v23, 1280, v23
  s_sub_u32 s15, s15, 1
  s_cmp_lg_u32 s15, 0
  s_cbranch_scc1 L_vloop
  ds_read_b128 v[68:71], v23 offset:128
  s_waitcnt lgkmcnt(1)
  s_nop 0
  v_and_b32 v56, v64, v16
  v_and_b32 v57, v64, v17
  v_and_b32 v58, v64, v18
  v_and_b32 v59, v64, v19
  s_waitcnt vmcnt(9)
  s_nop 0
  v_mfma_f32_16x16x32_bf16 v[52:55], v[56:59], v[104:107], v[52:55]
  buffer_load_dwordx4 v[104:107], v21, s[44:47], s48 offen offset:2048 nt
  v_and_b32 v60, v65, v16
  v_and_b32 v61, v65, v17
  v_and_b32 v62, v65, v18
  v_and_b32 v63, v65, v19
  s_waitcnt vmcnt(9)
  s_nop 0
  v_mfma_f32_16x16x32_bf16 v[52:55], v[60:63], v[108:111], v[52:55]
  buffer_load_dwordx4 v[108:111], v21, s[44:47], s48 offen offset:3072 nt
  s_add_u32 s48, s48, 8192
  v_and_b32 v56, v66, v16
  v_and_b32 v57, v66, v17
  v_and_b32 v58, v66, v18
  v_and_b32 v59, v66, v19
  s_waitcnt vmcnt(9)
  s_nop 0
  v_mfma_f32_16x16x32_bf16 v[52:55], v[56:59], v[112:115], v[52:55]
  buffer_load_dwordx4 v[112:115], v21, s[44:47], s48 offen offset:0 nt
  v_and_b32 v60, v67, v16
  v_and_b32 v61, v67, v17
  v_and_b32 v62, v67, v18
  v_and_b32 v63, v67, v19
  s_waitcnt vmcnt(9)
  s_nop 0
  v_mfma_f32_16x16x32_bf16 v[52:55], v[60:63], v[116:119], v[52:55]
  buffer_load_dwordx4 v[116:119], v21, s[44:47], s48 offen offset:1024 nt
  ds_read_b128 v[64:67], v23 offset:256
  s_waitcnt lgkmcnt(1)
  s_nop 0
  v_and_b32 v56, v68, v16
  v_and_b32 v57, v68, v17
  v_and_b32 v58, v68, v18
  v_and_b32 v59, v68, v19
  s_waitcnt vmcnt(9)
  s_nop 0
  v_mfma_f32_16x16x32_bf16 v[52:55], v[56:59], v[120:123], v[52:55]
  buffer_load_dwordx4 v[120:123], v21, s[44:47], s48 offen offset:2048 nt
  v_and_b32 v60, v69, v16
  v_and_b32 v61, v69, v17
  v_and_b32 v62, v69, v18
  v_and_b32 v63, v69, v19
  s_waitcnt vmcnt(9)
  s_nop 0
  v_mfma_f32_16x16x32_bf16 v[52:55], v[60:63], v[124:127], v[52:55]
  buffer_load_dwordx4 v[124:127], v21, s[44:47], s48 offen offset:3072 nt
  s_add_u32 s48, s48, 8192
  v_and_b32 v56, v70, v16
  v_and_b32 v57, v70, v17
  v_and_b32 v58, v70, v18
  v_and_b32 v59, v70, v19
  s_waitcnt vmcnt(9)
  s_nop 0
  v_mfma_f32_16x16x32_bf16 v[52:55], v[56:59], v[128:131], v[52:55]
  buffer_load_dwordx4 v[128:131], v21, s[44:47], s48 offen offset:0 nt
  v_and_b32 v60, v71, v16
  v_and_b32 v61, v71, v17
  v_and_b32 v62, v71, v18
  v_and_b32 v63, v71, v19
  s_waitcnt vmcnt(9)
  s_nop 0
  v_mfma_f32_16x16x32_bf16 v[52:55], v[60:63], v[132:135], v[52:55]
  buffer_load_dwordx4 v[132:135], v21, s[44:47], s48 offen offset:1024 nt
  ds_read_b128 v[68:71], v23 offset:384
  s_waitcnt lgkmcnt(1)
  s_nop 0
  v_and_b32 v56, v64, v16
  v_and_b32 v57, v64, v17
  v_and_b32 v58, v64, v18
  v_and_b32 v59, v64, v19
  s_waitcnt vmcnt(9)
  s_nop 0
  v_mfma_f32_16x16x32_bf16 v[52:55], v[56:59], v[96:99], v[52:55]
  buffer_load_dwordx4 v[96:99], v21, s[44:47], s48 offen offset:2048 nt
  v_and_b32 v60, v65, v16
  v_and_b32 v61, v65, v17
  v_and_b32 v62, v65, v18
  v_and_b32 v63, v65, v19
  s_waitcnt vmcnt(9)
  s_nop 0
  v_mfma_f32_16x16x32_bf16 v[52:55], v[60:63], v[100:103], v[52:55]
  buffer_load_dwordx4 v[100:103], v21, s[44:47], s48 offen offset:3072 nt
  s_add_u32 s48, s48, 8192
  v_and_b32 v56, v66, v16
  v_and_b32 v57, v66, v17
  v_and_b32 v58, v66, v18
  v_and_b32 v59, v66, v19
  s_waitcnt vmcnt(9)
  s_nop 0
  v_mfma_f32_16x16x32_bf16 v[52:55], v[56:59], v[104:107], v[52:55]
  v_and_b32 v60, v67, v16
  v_and_b32 v61, v67, v17
  v_and_b32 v62, v67, v18
  v_and_b32 v63, v67, v19
  s_waitcnt vmcnt(8)
  s_nop 0
  v_mfma_f32_16x16x32_bf16 v[52:55], v[60:63], v[108:111], v[52:55]
  ds_read_b128 v[64:67], v23 offset:512
  s_waitcnt lgkmcnt(1)
  s_nop 0
  v_and_b32 v56, v68, v16
  v_and_b32 v57, v68, v17
  v_and_b32 v58, v68, v18
  v_and_b32 v59, v68, v19
  s_waitcnt vmcnt(7)
  s_nop 0
  v_mfma_f32_16x16x32_bf16 v[52:55], v[56:59], v[112:115], v[52:55]
  v_and_b32 v60, v69, v16
  v_and_b32 v61, v69, v17
  v_and_b32 v62, v69, v18
  v_and_b32 v63, v69, v19
  s_waitcnt vmcnt(6)
  s_nop 0
  v_mfma_f32_16x16x32_bf16 v[52:55], v[60:63], v[116:119], v[52:55]
  v_and_b32 v56, v70, v16
  v_and_b32 v57, v70, v17
  v_and_b32 v58, v70, v18
  v_and_b32 v59, v70, v19
  s_waitcnt vmcnt(5)
  s_nop 0
  v_mfma_f32_16x16x32_bf16 v[52:55], v[56:59], v[120:123], v[52:55]
  v_and_b32 v60, v71, v16
  v_and_b32 v61, v71, v17
  v_and_b32 v62, v71, v18
  v_and_b32 v63, v71, v19
  s_waitcnt vmcnt(4)
  s_nop 0
  v_mfma_f32_16x16x32_bf16 v[52:55], v[60:63], v[124:127], v[52:55]
  s_waitcnt lgkmcnt(0)
  s_nop 0
  v_and_b32 v56, v64, v16
  v_and_b32 v57, v64, v17
  v_and_b32 v58, v64, v18
  v_and_b32 v59, v64, v19
  s_waitcnt vmcnt(3)
  s_nop 0
  v_mfma_f32_16x16x32_bf16 v[52:55], v[56:59], v[128:131], v[52:55]
  v_and_b32 v60, v65, v16
  v_and_b32 v61, v65, v17
  v_and_b32 v62, v65, v18
  v_and_b32 v63, v65, v19
  s_waitcnt vmcnt(2)
  s_nop 0
  v_mfma_f32_16x16x32_bf16 v[52:55], v[60:63], v[132:135], v[52:55]
  v_and_b32 v56, v66, v16
  v_and_b32 v57, v66, v17
  v_and_b32 v58, v66, v18
  v_and_b32 v59, v66, v19
  s_waitcnt vmcnt(1)
  s_nop 0
  v_mfma_f32_16x16x32_bf16 v[52:55], v[56:59], v[96:99], v[52:55]
  v_and_b32 v60, v67, v16
  v_and_b32 v61, v67, v17
  v_and_b32 v62, v67, v18
  v_and_b32 v63, v67, v19
  s_waitcnt vmcnt(0)
  s_nop 0
  v_mfma_f32_16x16x32_bf16 v[52:55], v[60:63], v[100:103], v[52:55]
  s_branch L_vdone
L_vdone:
  s_cmp_ge_u32 s3, 2
  s_cbranch_scc1 L_t0_b5
  s_nop 7
  s_mov_b32 exec_lo, -1
  s_mov_b32 exec_hi, 0
  ds_write_b128 v227, v[52:55]
  s_mov_b64 exec, -1
  s_waitcnt lgkmcnt(0)
L_t0_b5:
  s_barrier
  s_cmp_lg_u32 s3, 2
  s_cbranch_scc1 L_t1_done
  ds_read_b64 v[160:161], v228 offset:0
  ds_read_b64 v[162:163], v228 offset:512
  ds_read_b64 v[164:165], v228 offset:1024
  ds_read_b64 v[166:167], v228 offset:1536
  ds_read_b64 v[168:169], v228 offset:2048
  ds_read_b64 v[170:171], v228 offset:2560
  ds_read_b64 v[172:173], v228 offset:3072
  ds_read_b64 v[174:175], v228 offset:3584
  s_waitcnt lgkmcnt(0)
  v_pk_add_f32 v[160:161], v[160:161], v[162:163]
  v_pk_add_f32 v[164:165], v[164:165], v[166:167]
  v_pk_add_f32 v[168:169], v[168:169], v[170:171]
  v_pk_add_f32 v[172:173], v[172:173], v[174:175]
  v_pk_add_f32 v[160:161], v[160:161], v[164:165]
  v_pk_add_f32 v[168:169], v[168:169], v[172:173]
  v_pk_add_f32 v[160:161], v[160:161], v[168:169]
  v_cvt_pk_bf16_f32 v160, v160, v161
  v_min_u32 v160, -2, v160
  s_cmp_eq_u32 s49, 0
  s_cbranch_scc1 L_st_slow_9
  global_store_dword v208, v160, s[38:39]
  s_branch L_st_done_10
L_st_slow_9:
  global_store_dword v208, v160, s[38:39] sc1
L_st_done_10:
L_t1_done:
  s_cmp_ge_u32 s3, 2
  s_cbranch_scc1 L_t2_go
  s_lshl_b32 s52, s3, 12
  s_add_u32 s53, s52, 0
  v_add_u32 v13, s53, v229
  ds_read_b64_tr_b16 v[96:97], v13 offset:0
  ds_read_b64_tr_b16 v[98:99], v13 offset:512
  ds_read_b64_tr_b16 v[100:101], v13 offset:32
  ds_read_b64_tr_b16 v[102:103], v13 offset:544
  ds_read_b64_tr_b16 v[104:105], v13 offset:64
  ds_read_b64_tr_b16 v[106:107], v13 offset:576
  ds_read_b64_tr_b16 v[108:109], v13 offset:96
  ds_read_b64_tr_b16 v[110:111], v13 offset:608
  s_lshr_b32 s52, s3, 2
  s_lshl_b32 s52, s52, 15
  s_and_b32 s53, s3, 3
  s_lshl_b32 s53, s53, 5
  s_add_u32 s52, s52, s53
  s_add_u32 s52, s52, 32768
  v_add_u32 v15, s52, v229
  ds_read_b64_tr_b16 v[112:113], v15 offset:0
  ds_read_b64_tr_b16 v[114:115], v15 offset:512
  ds_read_b64_tr_b16 v[116:117], v15 offset:4096
  ds_read_b64_tr_b16 v[118:119], v15 offset:4608
  ds_read_b64_tr_b16 v[120:121], v15 offset:8192
  ds_read_b64_tr_b16 v[122:123], v15 offset:8704
  ds_read_b64_tr_b16 v[124:125], v15 offset:12288
  ds_read_b64_tr_b16 v[126:127], v15 offset:12800
  ds_read_b64_tr_b16 v[128:129], v15 offset:16384
  ds_read_b64_tr_b16 v[130:131], v15 offset:16896
  ds_read_b64_tr_b16 v[132:133], v15 offset:20480
  ds_read_b64_tr_b16 v[134:135], v15 offset:20992
  ds_read_b64_tr_b16 v[136:137], v15 offset:24576
  ds_read_b64_tr_b16 v[138:139], v15 offset:25088
  ds_read_b64_tr_b16 v[140:141], v15 offset:28672
  ds_read_b64_tr_b16 v[142:143], v15 offset:29184
  s_lshl_b32 s52, s3, 12
  s_add_u32 s53, s52, 98304
  v_add_u32 v11, s53, v229
  ds_read_b64_tr_b16 v[144:145], v11 offset:0
  ds_read_b64_tr_b16 v[146:147], v11 offset:512
  ds_read_b64_tr_b16 v[148:149], v11 offset:32
  ds_read_b64_tr_b16 v[150:151], v11 offset:544
  ds_read_b64_tr_b16 v[152:153], v11 offset:64
  ds_read_b64_tr_b16 v[154:155], v11 offset:576
  ds_read_b64_tr_b16 v[156:157], v11 offset:96
  ds_read_b64_tr_b16 v[158:159], v11 offset:608
L_t2_go:
  s_mov_b64 s[62:63], exec
  s_mov_b32 s50, 1048576
L_t2_poll_11:
  global_load_dwordx4 v[192:195], v209, s[38:39] sc1
  s_waitcnt vmcnt(0)
  v_max3_u32 v95, v192, v193, v194
  v_max_u32 v95, v95, v195
  v_cmp_eq_u32 vcc, -1, v95
  s_mov_b64 exec, vcc
  s_cbranch_execz L_t2_ok_12
  s_sub_u32 s50, s50, 1
  s_cmp_lg_u32 s50, 0
  s_cbranch_scc1 L_t2_poll_11
L_t2_ok_12:
  s_mov_b64 exec, s[62:63]
  s_waitcnt lgkmcnt(0)
  v_mfma_f32_16x16x32_bf16 v[160:163], v[96:99], v[192:195], 0
  v_mfma_f32_16x16x32_bf16 v[164:167], v[100:103], v[192:195], 0
  v_mfma_f32_16x16x32_bf16 v[168:171], v[104:107], v[192:195], 0
  v_mfma_f32_16x16x32_bf16 v[172:175], v[108:111], v[192:195], 0
  s_mov_b32 exec_lo, 0x00ff00ff
  s_mov_b32 exec_hi, 0x00ff00ff
  s_nop 2
  ds_write_b128 v210, v[160:163] offset:0
  ds_write_b128 v210, v[164:167] offset:64
  ds_write_b128 v210, v[168:171] offset:128
  ds_write_b128 v210, v[172:175] offset:192
  s_mov_b64 exec, -1
L_t2_nw:
  s_waitcnt lgkmcnt(0)
  s_barrier
  s_sub_u32 s52, s3, 2
  s_cmp_ge_u32 s52, 2
  s_cbranch_scc1 L_t2_skip
  ds_read_b128 v[160:163], v211 offset:0
  ds_read_b128 v[164:167], v211 offset:2048
  ds_read_b128 v[168:171], v211 offset:4096
  ds_read_b128 v[172:175], v211 offset:6144
  ds_read_b128 v[176:179], v211 offset:8192
  ds_read_b128 v[180:183], v211 offset:10240
  ds_read_b128 v[184:187], v211 offset:12288
  ds_read_b128 v[188:191], v211 offset:14336
  s_waitcnt lgkmcnt(0)
  v_pk_add_f32 v[160:161], v[160:161], v[164:165]
  v_pk_add_f32 v[162:163], v[162:163], v[166:167]
  v_pk_add_f32 v[168:169], v[168:169], v[172:173]
  v_pk_add_f32 v[170:171], v[170:171], v[174:175]
  v_pk_add_f32 v[176:177], v[176:177], v[180:181]
  v_pk_add_f32 v[178:179], v[178:179], v[182:183]
  v_pk_add_f32 v[184:185], v[184:185], v[188:189]
  v_pk_add_f32 v[186:187], v[186:187], v[190:191]
  v_pk_add_f32 v[160:161], v[160:161], v[168:169]
  v_pk_add_f32 v[162:163], v[162:163], v[170:171]
  v_pk_add_f32 v[176:177], v[176:177], v[184:185]
  v_pk_add_f32 v[178:179], v[178:179], v[186:187]
  v_pk_add_f32 v[160:161], v[160:161], v[176:177]
  v_pk_add_f32 v[162:163], v[162:163], v[178:179]
  v_min_u32 v160, -2, v160
  v_min_u32 v161, -2, v161
  v_min_u32 v162, -2, v162
  v_min_u32 v163, -2, v163
  global_store_dwordx4 v212, v[160:163], s[38:39] sc1
L_t2_skip:
  s_sleep 9
  s_mov_b64 s[62:63], exec
  s_mov_b32 s50, 1048576
L_t3_poll_13:
  global_load_dwordx4 v[192:195], v213, s[38:39] sc1
  global_load_dwordx4 v[196:199], v214, s[38:39] sc1
  s_waitcnt vmcnt(0)
  v_max3_u32 v95, v192, v193, v194
  v_max3_u32 v95, v95, v195, v196
  v_max3_u32 v95, v95, v197, v198
  v_max_u32 v95, v95, v199
  v_cmp_eq_u32 vcc, -1, v95
  s_mov_b64 exec, vcc
  s_cbranch_execz L_t3_ok_14
  s_sub_u32 s50, s50, 1
  s_cmp_lg_u32 s50, 0
  s_cbranch_scc1 L_t3_poll_13
L_t3_ok_14:
  s_mov_b64 exec, s[62:63]
  v_pk_add_f32 v[200:201], v[192:193], v[196:197]
  v_pk_add_f32 v[202:203], v[194:195], v[198:199]
  ds_write_b128 v215, v[200:203]
  s_waitcnt lgkmcnt(0)
  s_barrier
  s_cmp_lg_u32 s3, 3
  s_cbranch_scc1 L_t3_skip
  ds_read_b128 v[160:163], v216 offset:0
  ds_read_b128 v[164:167], v216 offset:1024
  ds_read_b128 v[168:171], v216 offset:2048
  ds_read_b128 v[172:175], v216 offset:3072
  ds_read_b128 v[176:179], v216 offset:4096
  ds_read_b128 v[180:183], v216 offset:5120
  ds_read_b128 v[184:187], v216 offset:6144
  ds_read_b128 v[188:191], v216 offset:7168
  v_lshlrev_b32 v200, 16, v244
  v_and_b32 v201, 0xffff0000, v244
  v_lshlrev_b32 v202, 16, v245
  v_and_b32 v203, 0xffff0000, v245
  s_waitcnt lgkmcnt(0)
  v_pk_add_f32 v[160:161], v[160:161], v[164:165]
  v_pk_add_f32 v[162:163], v[162:163], v[166:167]
  v_pk_add_f32 v[168:169], v[168:169], v[172:173]
  v_pk_add_f32 v[170:171], v[170:171], v[174:175]
  v_pk_add_f32 v[176:177], v[176:177], v[180:181]
  v_pk_add_f32 v[178:179], v[178:179], v[182:183]
  v_pk_add_f32 v[184:185], v[184:185], v[188:189]
  v_pk_add_f32 v[186:187], v[186:187], v[190:191]
  v_pk_add_f32 v[160:161], v[160:161], v[168:169]
  v_pk_add_f32 v[162:163], v[162:163], v[170:171]
  v_pk_add_f32 v[176:177], v[176:177], v[184:185]
  v_pk_add_f32 v[178:179], v[178:179], v[186:187]
  v_pk_add_f32 v[160:161], v[160:161], v[176:177]
  v_pk_add_f32 v[162:163], v[162:163], v[178:179]
  v_cvt_pk_bf16_f32 v164, v160, v161
  v_cvt_pk_bf16_f32 v165, v162, v163
  v_lshlrev_b32 v168, 16, v164
  v_and_b32 v169, 0xffff0000, v164
  v_lshlrev_b32 v170, 16, v165
  v_and_b32 v171, 0xffff0000, v165
  v_pk_add_f32 v[168:169], v[168:169], v[200:201]
  v_pk_add_f32 v[170:171], v[170:171], v[202:203]
  v_cvt_pk_bf16_f32 v166, v168, v169
  v_cvt_pk_bf16_f32 v167, v170, v171
  v_min_u32 v166, -2, v166
  v_min_u32 v167, -2, v167
  s_cmp_eq_u32 s49, 0
  s_cbranch_scc1 L_st_slow_15
  global_store_dwordx2 v217, v[166:167], s[38:39]
  s_branch L_st_done_16
L_st_slow_15:
  global_store_dwordx2 v217, v[166:167], s[38:39] sc1
L_st_done_16:
L_t3_skip:
  s_sleep 4
  s_mov_b64 s[62:63], exec
  s_mov_b32 s50, 1048576
L_t4_poll_17:
  global_load_dwordx4 v[160:163], v218, s[38:39] sc1
  global_load_dwordx4 v[164:167], v218, s[38:39] offset:16 sc1
  s_waitcnt vmcnt(0)
  v_max3_u32 v95, v160, v161, v162
  v_max3_u32 v95, v95, v163, v164
  v_max3_u32 v95, v95, v165, v166
  v_max_u32 v95, v95, v167
  v_cmp_eq_u32 vcc, -1, v95
  s_mov_b64 exec, vcc
  s_cbranch_execz L_t4_ok_18
  s_sub_u32 s50, s50, 1
  s_cmp_lg_u32 s50, 0
  s_cbranch_scc1 L_t4_poll_17
L_t4_ok_18:
  s_mov_b64 exec, s[62:63]
  s_cmp_lg_u32 s3, s4
  s_cbranch_scc1 L_t4_nohs
  s_mov_b64 exec, s[10:11]
  ds_write_b128 v220, v[160:163]
  ds_write_b128 v220, v[164:167] offset:16
  s_mov_b64 exec, -1
L_t4_nohs:
  s_cmp_ge_u32 s5, 28
  s_cbranch_scc1 L_t5_skip_all
  v_lshlrev_b32 v168, 16, v160
  v_and_b32 v169, 0xffff0000, v160
  v_lshlrev_b32 v170, 16, v161
  v_and_b32 v171, 0xffff0000, v161
  v_lshlrev_b32 v172, 16, v162
  v_and_b32 v173, 0xffff0000, v162
  v_lshlrev_b32 v174, 16, v163
  v_and_b32 v175, 0xffff0000, v163
  v_lshlrev_b32 v176, 16, v164
  v_and_b32 v177, 0xffff0000, v164
  v_lshlrev_b32 v178, 16, v165
  v_and_b32 v179, 0xffff0000, v165
  v_lshlrev_b32 v180, 16, v166
  v_and_b32 v181, 0xffff0000, v166
  v_lshlrev_b32 v182, 16, v167
  v_and_b32 v183, 0xffff0000, v167
  v_readfirstlane_b32 s56, v168
  s_nop 1
  v_mov_b32 v78, s56
  v_mov_b32 v79, s56
  v_pk_add_f32 v[168:169], v[168:169], v[78:79] neg_lo:[0,1] neg_hi:[0,1]
  v_pk_add_f32 v[170:171], v[170:171], v[78:79] neg_lo:[0,1] neg_hi:[0,1]
  v_pk_add_f32 v[172:173], v[172:173], v[78:79] neg_lo:[0,1] neg_hi:[0,1]
  v_pk_add_f32 v[174:175], v[174:175], v[78:79] neg_lo:[0,1] neg_hi:[0,1]
  v_pk_add_f32 v[176:177], v[176:177], v[78:79] neg_lo:[0,1] neg_hi:[0,1]
  v_pk_add_f32 v[178:179], v[178:179], v[78:79] neg_lo:[0,1] neg_hi:[0,1]
  v_pk_add_f32 v[180:181], v[180:181], v[78:79] neg_lo:[0,1] neg_hi:[0,1]
  v_pk_add_f32 v[182:183], v[182:183], v[78:79] neg_lo:[0,1] neg_hi:[0,1]
  v_pk_add_f32 v[72:73], v[168:169], v[170:171]
  v_pk_mul_f32 v[74:75], v[168:169], v[168:169]
  v_pk_fma_f32 v[74:75], v[170:171], v[170:171], v[74:75]
  v_pk_add_f32 v[72:73], v[72:73], v[172:173]
  v_pk_fma_f32 v[74:75], v[172:173], v[172:173], v[74:75]
  v_pk_add_f32 v[72:73], v[72:73], v[174:175]
  v_pk_fma_f32 v[74:75], v[174:175], v[174:175], v[74:75]
  v_pk_add_f32 v[72:73], v[72:73], v[176:177]
  v_pk_fma_f32 v[74:75], v[176:177], v[176:177], v[74:75]
  v_pk_add_f32 v[72:73], v[72:73], v[178:179]
  v_pk_fma_f32 v[74:75], v[178:179], v[178:179], v[74:75]
  v_pk_add_f32 v[72:73], v[72:73], v[180:181]
  v_pk_fma_f32 v[74:75], v[180:181], v[180:181], v[74:75]
  v_pk_add_f32 v[72:73], v[72:73], v[182:183]
  v_pk_fma_f32 v[74:75], v[182:183], v[182:183], v[74:75]
  v_add_f32 v72, v72, v73
  v_add_f32 v74, v74, v75
  s_nop 0
  v_add_f32_dpp v72, v72, v72 row_ror:8 row_mask:0xf bank_mask:0xf
  v_add_f32_dpp v74, v74, v74 row_ror:8 row_mask:0xf bank_mask:0xf
  s_nop 0
  v_add_f32_dpp v72, v72, v72 row_ror:4 row_mask:0xf bank_mask:0xf
  v_add_f32_dpp v74, v74, v74 row_ror:4 row_mask:0xf bank_mask:0xf
  s_nop 0
  v_add_f32_dpp v72, v72, v72 row_ror:2 row_mask:0xf bank_mask:0xf
  v_add_f32_dpp v74, v74, v74 row_ror:2 row_mask:0xf bank_mask:0xf
  s_nop 0
  v_add_f32_dpp v72, v72, v72 row_ror:1 row_mask:0xf bank_mask:0xf
  v_add_f32_dpp v74, v74, v74 row_ror:1 row_mask:0xf bank_mask:0xf
  v_mov_b32 v73, v72
  v_mov_b32 v75, v74
  s_nop 1
  v_permlane16_swap_b32 v72, v73
  v_permlane16_swap_b32 v74, v75
  s_nop 1
  v_add_f32 v72, v72, v73
  v_add_f32 v74, v74, v75
  v_mov_b32 v73, v72
  v_mov_b32 v75, v74
  s_nop 1
  v_permlane32_swap_b32 v72, v73
  v_permlane32_swap_b32 v74, v75
  s_nop 1
  v_add_f32 v72, v72, v73
  v_add_f32 v74, v74, v75
  v_mul_f32 v72, 0x3a800000, v72
  v_mul_f32 v74, 0x3a800000, v74
  v_fma_f32 v74, -v72, v72, v74
  v_add_f32 v72, v72, v78
  v_max_f32 v74, 0, v74
  v_cvt_pk_bf16_f32 v72, v72, v74
  v_and_b32 v74, 0xffff0000, v72
  v_lshlrev_b32 v72, 16, v72
  v_add_f32 v74, 0x3727c5ac, v74
  v_cvt_pk_bf16_f32 v74, v74, v74
  v_and_b32 v74, 0xffff0000, v74
  v_sqrt_f32 v74, v74
  v_mov_b32 v73, v72
  v_cvt_pk_bf16_f32 v74, v74, v74
  v_and_b32 v74, 0xffff0000, v74
  v_rcp_f32 v74, v74
  s_nop 0
  v_mov_b32 v75, v74
  v_lshlrev_b32 v168, 16, v160
  v_and_b32 v169, 0xffff0000, v160
  v_pk_add_f32 v[168:169], v[168:169], v[72:73] neg_lo:[0,1] neg_hi:[0,1]
  v_cvt_pk_bf16_f32 v76, v168, v169
  v_lshlrev_b32 v168, 16, v76
  v_and_b32 v169, 0xffff0000, v76
  v_pk_mul_f32 v[168:169], v[168:169], v[74:75]
  v_cvt_pk_bf16_f32 v184, v168, v169
  v_lshlrev_b32 v170, 16, v161
  v_and_b32 v171, 0xffff0000, v161
  v_pk_add_f32 v[170:171], v[170:171], v[72:73] neg_lo:[0,1] neg_hi:[0,1]
  v_cvt_pk_bf16_f32 v76, v170, v171
  v_lshlrev_b32 v170, 16, v76
  v_and_b32 v171, 0xffff0000, v76
  v_pk_mul_f32 v[170:171], v[170:171], v[74:75]
  v_cvt_pk_bf16_f32 v185, v170, v171
  v_lshlrev_b32 v172, 16, v162
  v_and_b32 v173, 0xffff0000, v162
  v_pk_add_f32 v[172:173], v[172:173], v[72:73] neg_lo:[0,1] neg_hi:[0,1]
  v_cvt_pk_bf16_f32 v76, v172, v173
  v_lshlrev_b32 v172, 16, v76
  v_and_b32 v173, 0xffff0000, v76
  v_pk_mul_f32 v[172:173], v[172:173], v[74:75]
  v_cvt_pk_bf16_f32 v186, v172, v173
  v_lshlrev_b32 v174, 16, v163
  v_and_b32 v175, 0xffff0000, v163
  v_pk_add_f32 v[174:175], v[174:175], v[72:73] neg_lo:[0,1] neg_hi:[0,1]
  v_cvt_pk_bf16_f32 v76, v174, v175
  v_lshlrev_b32 v174, 16, v76
  v_and_b32 v175, 0xffff0000, v76
  v_pk_mul_f32 v[174:175], v[174:175], v[74:75]
  v_cvt_pk_bf16_f32 v187, v174, v175
  v_lshlrev_b32 v176, 16, v164
  v_and_b32 v177, 0xffff0000, v164
  v_pk_add_f32 v[176:177], v[176:177], v[72:73] neg_lo:[0,1] neg_hi:[0,1]
  v_cvt_pk_bf16_f32 v76, v176, v177
  v_lshlrev_b32 v176, 16, v76
  v_and_b32 v177, 0xffff0000, v76
  v_pk_mul_f32 v[176:177], v[176:177], v[74:75]
  v_cvt_pk_bf16_f32 v188, v176, v177
  v_lshlrev_b32 v178, 16, v165
  v_and_b32 v179, 0xffff0000, v165
  v_pk_add_f32 v[178:179], v[178:179], v[72:73] neg_lo:[0,1] neg_hi:[0,1]
  v_cvt_pk_bf16_f32 v76, v178, v179
  v_lshlrev_b32 v178, 16, v76
  v_and_b32 v179, 0xffff0000, v76
  v_pk_mul_f32 v[178:179], v[178:179], v[74:75]
  v_cvt_pk_bf16_f32 v189, v178, v179
  v_lshlrev_b32 v180, 16, v166
  v_and_b32 v181, 0xffff0000, v166
  v_pk_add_f32 v[180:181], v[180:181], v[72:73] neg_lo:[0,1] neg_hi:[0,1]
  v_cvt_pk_bf16_f32 v76, v180, v181
  v_lshlrev_b32 v180, 16, v76
  v_and_b32 v181, 0xffff0000, v76
  v_pk_mul_f32 v[180:181], v[180:181], v[74:75]
  v_cvt_pk_bf16_f32 v190, v180, v181
  v_lshlrev_b32 v182, 16, v167
  v_and_b32 v183, 0xffff0000, v167
  v_pk_add_f32 v[182:183], v[182:183], v[72:73] neg_lo:[0,1] neg_hi:[0,1]
  v_cvt_pk_bf16_f32 v76, v182, v183
  v_lshlrev_b32 v182, 16, v76
  v_and_b32 v183, 0xffff0000, v76
  v_pk_mul_f32 v[182:183], v[182:183], v[74:75]
  v_cvt_pk_bf16_f32 v191, v182, v183
  s_mov_b64 exec, s[8:9]
  ds_write_b128 v219, v[184:187]
  ds_write_b128 v219, v[188:191] offset:16
  s_mov_b64 exec, -1
  s_waitcnt lgkmcnt(0)
  s_barrier
  s_waitcnt vmcnt(0)
  ds_read_b128 v[160:163], v221 offset:0
  ds_read_b128 v[164:167], v221 offset:64
  ds_read_b128 v[168:171], v221 offset:128
  ds_read_b128 v[172:175], v221 offset:192
  ds_read_b128 v[176:179], v221 offset:256
  ds_read_b128 v[180:183], v221 offset:320
  ds_read_b128 v[184:187], v221 offset:384
  ds_read_b128 v[188:191], v221 offset:448
  s_waitcnt lgkmcnt(7)
  v_mfma_f32_16x16x32_bf16 v[72:75], v[112:115], v[160:163], 0
  s_waitcnt lgkmcnt(6)
  v_mfma_f32_16x16x32_bf16 v[76:79], v[116:119], v[164:167], 0
  s_waitcnt lgkmcnt(5)
  v_mfma_f32_16x16x32_bf16 v[72:75], v[120:123], v[168:171], v[72:75]
  s_waitcnt lgkmcnt(4)
  v_mfma_f32_16x16x32_bf16 v[76:79], v[124:127], v[172:175], v[76:79]
  s_waitcnt lgkmcnt(3)
  v_mfma_f32_16x16x32_bf16 v[72:75], v[128:131], v[176:179], v[72:75]
  s_waitcnt lgkmcnt(2)
  v_mfma_f32_16x16x32_bf16 v[76:79], v[132:135], v[180:183], v[76:79]
  s_waitcnt lgkmcnt(1)
  v_mfma_f32_16x16x32_bf16 v[72:75], v[136:139], v[184:187], v[72:75]
  s_waitcnt lgkmcnt(0)
  v_mfma_f32_16x16x32_bf16 v[76:79], v[140:143], v[188:191], v[76:79]
  s_nop 7
  v_pk_add_f32 v[72:73], v[72:73], v[76:77]
  v_pk_add_f32 v[74:75], v[74:75], v[78:79]
  v_min_u32 v72, -2, v72
  v_min_u32 v73, -2, v73
  v_min_u32 v74, -2, v74
  v_min_u32 v75, -2, v75
  s_mov_b32 exec_lo, 0x00ff00ff
  s_mov_b32 exec_hi, 0x00ff00ff
  s_cmp_eq_u32 s49, 0
  s_cbranch_scc1 L_st_slow_19
  global_store_dwordx4 v222, v[72:75], s[38:39]
  s_branch L_st_done_20
L_st_slow_19:
  global_store_dwordx4 v222, v[72:75], s[38:39] sc1
L_st_done_20:
  s_mov_b64 exec, -1
  s_cmp_lg_u32 s3, 3
  s_cbranch_scc1 L_t5_skip_all
  s_mov_b32 s52, 0x3d372713
  s_mov_b32 s53, 0xc0135761
  s_sleep 5
  s_mov_b64 s[62:63], exec
  s_mov_b32 s50, 1048576
L_t5_poll_21:
  global_load_dwordx2 v[160:161], v232, s[38:39] offset:0 sc1
  global_load_dwordx2 v[162:163], v232, s[38:39] offset:2048 sc1
  global_load_dwordx2 v[164:165], v233, s[38:39] offset:0 sc1
  global_load_dwordx2 v[166:167], v233, s[38:39] offset:2048 sc1
  global_load_dwordx2 v[168:169], v234, s[38:39] offset:0 sc1
  global_load_dwordx2 v[170:171], v234, s[38:39] offset:2048 sc1
  global_load_dwordx2 v[172:173], v235, s[38:39] offset:0 sc1
  global_load_dwordx2 v[174:175], v235, s[38:39] offset:2048 sc1
  s_waitcnt vmcnt(0)
  v_max3_u32 v95, v160, v161, v162
  v_max3_u32 v95, v95, v163, v164
  v_max3_u32 v95, v95, v165, v166
  v_max3_u32 v95, v95, v167, v168
  v_max3_u32 v95, v95, v169, v170
  v_max3_u32 v95, v95, v171, v172
  v_max3_u32 v95, v95, v173, v174
  v_max_u32 v95, v95, v175
  v_cmp_eq_u32 vcc, -1, v95
  s_mov_b64 exec, vcc
  s_cbranch_execz L_t5_ok_22
  s_sub_u32 s50, s50, 1
  s_cmp_lg_u32 s50, 0
  s_cbranch_scc1 L_t5_poll_21
L_t5_ok_22:
  s_mov_b64 exec, s[62:63]
  v_pk_add_f32 v[176:177], v[160:161], v[164:165]
  v_pk_add_f32 v[180:181], v[168:169], v[172:173]
  v_pk_add_f32 v[176:177], v[176:177], v[180:181]
  v_pk_add_f32 v[178:179], v[162:163], v[166:167]
  v_pk_add_f32 v[182:183], v[170:171], v[174:175]
  v_pk_add_f32 v[178:179], v[178:179], v[182:183]
  v_cvt_pk_bf16_f32 v184, v176, v177
  v_cvt_pk_bf16_f32 v185, v178, v179
  v_lshlrev_b32 v176, 16, v184
  v_and_b32 v177, 0xffff0000, v184
  v_lshlrev_b32 v178, 16, v185
  v_and_b32 v179, 0xffff0000, v185
  v_pk_mul_f32 v[180:181], v[176:177], v[176:177]
  v_pk_mul_f32 v[180:181], v[180:181], v[176:177]
  v_fma_f32 v180, v180, s52, v176
  v_fma_f32 v181, v181, s52, v177
  v_mul_f32 v180, s53, v180
  v_mul_f32 v181, s53, v181
  v_exp_f32 v180, v180
  v_exp_f32 v181, v181
  s_nop 0
  v_add_f32 v180, 1.0, v180
  v_add_f32 v181, 1.0, v181
  v_rcp_f32 v180, v180
  v_rcp_f32 v181, v181
  s_nop 0
  v_pk_mul_f32 v[180:181], v[180:181], v[176:177]
  v_cvt_pk_bf16_f32 v184, v180, v181
  v_lshlrev_b32 v180, 16, v184
  v_and_b32 v181, 0xffff0000, v184
  v_pk_mul_f32 v[180:181], v[180:181], v[178:179]
  v_cvt_pk_bf16_f32 v180, v180, v181
  v_min_u32 v180, -2, v180
  s_cmp_eq_u32 s49, 0
  s_cbranch_scc1 L_st_slow_23
  global_store_dword v223, v180, s[38:39]
  s_branch L_st_done_24
L_st_slow_23:
  global_store_dword v223, v180, s[38:39] sc1
L_st_done_24:
L_t5_skip_all:
  s_cmp_ge_u32 s3, 7
  s_cbranch_scc1 L_t6_nopoll
  s_sleep 4
  s_mov_b64 s[62:63], exec
  s_mov_b32 s50, 1048576
L_t6_poll_25:
  global_load_dwordx4 v[192:195], v224, s[38:39] sc1
  s_waitcnt vmcnt(0)
  v_max3_u32 v95, v192, v193, v194
  v_max_u32 v95, v95, v195
  v_cmp_eq_u32 vcc, -1, v95
  s_mov_b64 exec, vcc
  s_cbranch_execz L_t6_ok_26
  s_sub_u32 s50, s50, 1
  s_cmp_lg_u32 s50, 0
  s_cbranch_scc1 L_t6_poll_25
L_t6_ok_26:
  s_mov_b64 exec, s[62:63]
L_t6_nopoll:
  v_mfma_f32_16x16x32_bf16 v[160:163], v[144:147], v[192:195], 0
  v_mfma_f32_16x16x32_bf16 v[164:167], v[148:151], v[192:195], 0
  v_mfma_f32_16x16x32_bf16 v[168:171], v[152:155], v[192:195], 0
  v_mfma_f32_16x16x32_bf16 v[172:175], v[156:159], v[192:195], 0
  s_cmp_ge_u32 s3, 7
  s_cbranch_scc1 L_t6_nw
  s_mov_b32 exec_lo, 0x00ff00ff
  s_mov_b32 exec_hi, 0x00ff00ff
  s_nop 2
  ds_write_b128 v210, v[160:163] offset:16384
  ds_write_b128 v210, v[164:167] offset:16448
  ds_write_b128 v210, v[168:171] offset:16512
  ds_write_b128 v210, v[172:175] offset:16576
  s_mov_b64 exec, -1
L_t6_nw:
  s_waitcnt lgkmcnt(0)
  s_barrier
  s_sub_u32 s52, s3, 2
  s_cmp_ge_u32 s52, 2
  s_cbranch_scc1 L_t6_skip
  ds_read_b128 v[160:163], v211 offset:16384
  ds_read_b128 v[164:167], v211 offset:18432
  ds_read_b128 v[168:171], v211 offset:20480
  ds_read_b128 v[172:175], v211 offset:22528
  ds_read_b128 v[176:179], v211 offset:24576
  ds_read_b128 v[180:183], v211 offset:26624
  ds_read_b128 v[184:187], v211 offset:28672
  v_add_u32 v10, 4194304, v212
  s_waitcnt lgkmcnt(0)
  v_pk_add_f32 v[160:161], v[160:161], v[164:165]
  v_pk_add_f32 v[162:163], v[162:163], v[166:167]
  v_pk_add_f32 v[168:169], v[168:169], v[172:173]
  v_pk_add_f32 v[170:171], v[170:171], v[174:175]
  v_pk_add_f32 v[176:177], v[176:177], v[180:181]
  v_pk_add_f32 v[178:179], v[178:179], v[182:183]
  v_pk_add_f32 v[160:161], v[160:161], v[168:169]
  v_pk_add_f32 v[162:163], v[162:163], v[170:171]
  v_pk_add_f32 v[176:177], v[176:177], v[184:185]
  v_pk_add_f32 v[178:179], v[178:179], v[186:187]
  v_pk_add_f32 v[160:161], v[160:161], v[176:177]
  v_pk_add_f32 v[162:163], v[162:163], v[178:179]
  v_min_u32 v160, -2, v160
  v_min_u32 v161, -2, v161
  v_min_u32 v162, -2, v162
  v_min_u32 v163, -2, v163
  global_store_dwordx4 v10, v[160:163], s[38:39] sc1
L_t6_skip:
  s_cmp_lg_u32 s3, 3
  s_cbranch_scc1 L_fin
  ds_read_u16 v170, v226
  s_sleep 9
  s_mov_b64 s[62:63], exec
  s_mov_b32 s50, 1048576
L_t7_poll_27:
  global_load_dword v160, v236, s[38:39] sc1
  global_load_dword v161, v237, s[38:39] sc1
  global_load_dword v162, v238, s[38:39] sc1
  global_load_dword v163, v239, s[38:39] sc1
  global_load_dword v164, v240, s[38:39] sc1
  global_load_dword v165, v241, s[38:39] sc1
  global_load_dword v166, v242, s[38:39] sc1
  global_load_dword v167, v243, s[38:39] sc1
  s_waitcnt vmcnt(0)
  v_max3_u32 v95, v160, v161, v162
  v_max3_u32 v95, v95, v163, v164
  v_max3_u32 v95, v95, v165, v166
  v_max_u32 v95, v95, v167
  v_cmp_eq_u32 vcc, -1, v95
  s_mov_b64 exec, vcc
  s_cbranch_execz L_t7_ok_28
  s_sub_u32 s50, s50, 1
  s_cmp_lg_u32 s50, 0
  s_cbranch_scc1 L_t7_poll_27
L_t7_ok_28:
  s_mov_b64 exec, s[62:63]
  v_pk_add_f32 v[176:177], v[160:161], v[162:163]
  v_pk_add_f32 v[178:179], v[164:165], v[166:167]
  v_pk_add_f32 v[176:177], v[176:177], v[178:179]
  v_add_f32 v176, v176, v177
  v_mov_b32 v177, v176
  s_waitcnt lgkmcnt(0)
  s_nop 0
  v_permlane32_swap_b32 v176, v177
  v_lshlrev_b32 v170, 16, v170
  v_add_f32 v176, v176, v177
  v_cvt_pk_bf16_f32 v176, v176, v176
  v_and_b32 v176, 0xffff0000, v176
  v_add_f32 v176, v176, v170
  v_cvt_pk_bf16_f32 v176, v176, v176
  s_mov_b32 exec_lo, -1
  s_mov_b32 exec_hi, 0
  global_store_short v225, v176, s[34:35]
  s_mov_b64 exec, -1
  s_cmp_lg_u32 s2, 0
  s_cbranch_scc1 L_fin
  v_mov_b32 v10, 65536
  v_mov_b32 v12, s66
  v_mov_b32 v13, s67
  s_mov_b32 exec_lo, 1
  s_mov_b32 exec_hi, 0
  global_store_dwordx2 v10, v[12:13], s[38:39] sc1
  s_mov_b64 exec, -1
L_fin:
L_exit:
  s_endpgm
L_high2:
  s_cmp_lg_u32 s3, 7
  s_cbranch_scc1 L_h2_noclr
  v_mov_b32 v12, -1
  v_mov_b32 v13, -1
  v_mov_b32 v14, -1
  v_mov_b32 v15, -1
  s_lshr_b32 s56, s5, 4
  s_and_b32 s57, s5, 15
  s_lshl_b32 s53, s4, 1
  s_add_u32 s53, s53, s56
  s_mul_i32 s52, s53, 32768
  s_lshl_b32 s53, s57, 8
  s_add_u32 s52, s52, s53
  v_mul_u32_u24 v10, 4096, v3
  v_lshlrev_b32 v11, 4, v2
  v_add3_u32 v10, v10, v11, s52
  v_add_u32 v11, 33554432, v10
  global_store_dwordx4 v11, v[12:15], s[38:39] sc1
  v_add_u32 v11, 33554432+16384, v10
  global_store_dwordx4 v11, v[12:15], s[38:39] sc1
  v_add_u32 v11, 37748736, v10
  global_store_dwordx4 v11, v[12:15], s[38:39] sc1
  v_add_u32 v11, 37748736+16384, v10
  global_store_dwordx4 v11, v[12:15], s[38:39] sc1
  s_lshl_b32 s52, s6, 3
  s_add_u32 s52, s52, s7
  s_lshl_b32 s52, s52, 8
  s_add_u32 s52, s52, 1048576
  v_add_u32 v10, s52, v21
  s_mov_b32 exec_lo, 0xffff
  s_mov_b32 exec_hi, 0
  global_store_dwordx4 v10, v[12:15], s[38:39] sc1
  s_mov_b64 exec, -1
  s_lshr_b32 s52, s5, 2
  s_lshl_b32 s53, s4, 3
  s_add_u32 s52, s52, s53
  s_lshl_b32 s52, s52, 11
  s_and_b32 s53, s5, 3
  s_lshl_b32 s53, s53, 9
  s_add_u32 s52, s52, s53
  s_add_u32 s52, s52, 1703936
  v_add_u32 v10, s52, v21
  s_mov_b32 exec_lo, -1
  s_mov_b32 exec_hi, 0
  global_store_dwordx4 v10, v[12:15], s[38:39] sc1
  s_mov_b64 exec, -1
  s_cmp_ge_u32 s5, 28
  s_cbranch_scc1 L_clr_done7
  s_mul_i32 s52, s4, 28
  s_add_u32 s52, s52, s5
  s_lshl_b32 s52, s52, 12
  s_add_u32 s52, s52, 1835008
  v_add_u32 v10, s52, v21
  global_store_dwordx4 v10, v[12:15], s[38:39] offset:0 sc1
  global_store_dwordx4 v10, v[12:15], s[38:39] offset:1024 sc1
  global_store_dwordx4 v10, v[12:15], s[38:39] offset:2048 sc1
  global_store_dwordx4 v10, v[12:15], s[38:39] offset:3072 sc1
  s_mul_i32 s52, s5, 37
  s_lshr_b32 s52, s52, 8
  s_mul_i32 s53, s52, 7
  s_sub_u32 s53, s5, s53
  s_lshl_b32 s52, s52, 1
  s_lshl_b32 s54, s4, 3
  s_add_u32 s52, s52, s54
  s_mul_i32 s52, s52, 896
  s_lshl_b32 s53, s53, 7
  s_add_u32 s52, s52, s53
  s_add_u32 s52, s52, 2752512
  v_lshrrev_b32 v10, 3, v1
  v_mul_u32_u24 v10, 896, v10
  v_and_b32 v11, 7, v1
  v_lshlrev_b32 v11, 4, v11
  v_add3_u32 v10, v10, v11, s52
  s_mov_b32 exec_lo, 0xffff
  s_mov_b32 exec_hi, 0
  global_store_dwordx4 v10, v[12:15], s[38:39] sc1
  s_mov_b64 exec, -1
L_clr_done7:
L_h2_noclr:
  s_cmp_eq_u32 s12, 0
  s_cbranch_scc1 L_dma2_done
L_dma2_loop:
  s_waitcnt vmcnt(3)
  global_load_lds_dwordx4 v25, s[58:59] nt
  s_add_u32 m0, m0, 1024
  s_add_u32 s58, s58, s13
  s_addc_u32 s59, s59, 0
  s_sub_u32 s12, s12, 1
  s_cmp_eq_u32 s12, 16
  s_cselect_b32 s64, s14, 0
  s_add_u32 s58, s58, s64
  s_addc_u32 s59, s59, 0
  s_cmp_lg_u32 s12, 0
  s_cbranch_scc1 L_dma2_loop
L_dma2_done:
  s_waitcnt vmcnt(0)
  s_cmp_lg_u32 s3, 7
  s_cbranch_scc1 L_h2_nordy
  s_getreg_b32 s52, hwreg(HW_REG_XCC_ID, 0, 4)
  s_lshl_b32 s53, s4, 5
  s_add_u32 s53, s53, s5
  s_lshl_b32 s53, s53, 4
  s_add_u32 s53, s53, 0
  v_mov_b32 v10, s53
  v_mov_b32 v12, s52
  v_mov_b32 v13, 0
  v_mov_b32 v14, s66
  v_mov_b32 v15, s67
  s_mov_b32 exec_lo, 1
  s_mov_b32 exec_hi, 0
  global_store_dwordx4 v10, v[12:15], s[38:39] sc1
  s_mov_b64 exec, -1
L_h2_nordy:
  s_lshl_b32 s52, s6, 3
  s_add_u32 s52, s52, s7
  s_lshl_b32 s52, s52, 8
  s_add_u32 s52, s52, 1048576
  v_lshlrev_b32 v10, 2, v1
  v_add_u32 v208, s52, v10
  s_lshl_b32 s52, s3, 9
  s_add_u32 s52, s52, 143360
  v_lshlrev_b32 v11, 5, v2
  v_lshlrev_b32 v12, 4, v3
  v_add3_u32 v227, v11, v12, s52
  v_lshlrev_b32 v11, 3, v1
  v_add_u32 v228, 143360, v11
  v_lshlrev_b32 v11, 3, v3
  v_add_u32 v11, v11, v4
  v_lshlrev_b32 v11, 7, v11
  v_lshlrev_b32 v13, 3, v5
  v_add_u32 v229, v11, v13
  s_lshr_b32 s56, s5, 4
  s_and_b32 s57, s5, 15
  v_and_b32 v14, 7, v1
  s_lshl_b32 s52, s4, 2
  s_lshl_b32 s53, s56, 1
  s_add_u32 s52, s52, s53
  s_lshr_b32 s53, s3, 2
  s_add_u32 s52, s52, s53
  s_lshl_b32 s52, s52, 11
  s_and_b32 s53, s3, 3
  s_lshl_b32 s53, s53, 6
  s_add_u32 s52, s52, s53
  s_add_u32 s52, s52, 1048576
  v_lshlrev_b32 v10, 8, v14
  v_add3_u32 v209, v10, v12, s52
  s_lshl_b32 s52, s3, 11
  s_add_u32 s52, s52, 126976
  v_lshlrev_b32 v10, 8, v2
  v_xor_b32 v11, v3, v5
  v_lshlrev_b32 v11, 4, v11
  v_add3_u32 v210, v10, v11, s52
  s_sub_u32 s52, s3, 2
  s_lshl_b32 s52, s52, 6
  v_add_u32 v10, s52, v1
  v_and_b32 v10, 127, v10
  v_lshrrev_b32 v11, 4, v10
  v_and_b32 v13, 3, v11
  v_xor_b32 v13, v13, v10
  v_lshlrev_b32 v13, 4, v13
  v_add_u32 v211, 126976, v13
  s_lshl_b32 s52, s4, 1
  s_add_u32 s52, s52, s56
  s_mul_i32 s52, s52, 32768
  s_lshl_b32 s53, s57, 8
  s_add_u32 s52, s52, s53
  s_add_u32 s52, s52, 33554432
  v_lshrrev_b32 v11, 4, v10
  v_mul_u32_u24 v11, 4096, v11
  v_lshlrev_b32 v13, 4, v2
  v_add3_u32 v212, v11, v13, s52
  s_lshr_b32 s52, s5, 2
  s_mul_i32 s52, s52, 4096
  s_and_b32 s53, s5, 3
  s_lshl_b32 s53, s53, 10
  s_add_u32 s52, s52, s53
  s_mul_i32 s53, s3, 65536
  s_add_u32 s52, s52, s53
  s_add_u32 s52, s52, 33554432
  v_add_u32 v213, s52, v21
  v_add_u32 v214, 32768, v213
  s_lshl_b32 s52, s3, 10
  s_add_u32 s52, s52, 147456
  v_add_u32 v215, s52, v21
  v_add_u32 v216, 147456, v21
  s_lshr_b32 s52, s5, 2
  s_lshl_b32 s53, s4, 3
  s_add_u32 s52, s52, s53
  s_lshl_b32 s52, s52, 11
  s_and_b32 s53, s5, 3
  s_lshl_b32 s53, s53, 9
  s_add_u32 s52, s52, s53
  s_add_u32 s52, s52, 1703936
  v_lshlrev_b32 v10, 3, v1
  v_add_u32 v217, s52, v10
  s_lshr_b32 s52, s5, 2
  s_lshl_b32 s52, s52, 11
  s_add_u32 s52, s52, s53
  v_add_u32 v9, s52, v10
  s_lshl_b32 s52, s4, 3
  s_add_u32 s52, s52, s3
  s_lshl_b32 s52, s52, 11
  s_add_u32 s52, s52, 1703936
  v_lshlrev_b32 v10, 5, v1
  v_add_u32 v218, s52, v10
  s_mul_i32 s54, s5, 37
  s_lshr_b32 s54, s54, 8
  s_mul_i32 s55, s54, 7
  s_sub_u32 s55, s5, s55
  s_lshl_b32 s52, s54, 4
  v_subrev_u32 v10, s52, v1
  v_cmp_gt_u32 s[8:9], 16, v10
  s_mul_i32 s53, s3, 528
  s_add_u32 s53, s53, 126976
  v_lshlrev_b32 v10, 5, v10
  v_add_u32 v219, s53, v10
  s_lshl_b32 s52, s5, 1
  v_subrev_u32 v10, s52, v1
  v_cmp_gt_u32 s[10:11], 2, v10
  v_lshlrev_b32 v10, 5, v10
  v_add_u32 v220, 162208, v10
  v_mul_u32_u24 v10, 528, v14
  v_add_u32 v10, v10, v12
  v_add_u32 v221, 126976, v10
  s_mul_i32 s52, s4, 28
  s_add_u32 s52, s52, s5
  s_lshl_b32 s52, s52, 12
  s_lshr_b32 s53, s3, 2
  s_lshl_b32 s53, s53, 11
  s_add_u32 s52, s52, s53
  s_and_b32 s53, s3, 3
  s_lshl_b32 s53, s53, 9
  s_add_u32 s52, s52, s53
  s_add_u32 s52, s52, 1835008
  v_lshlrev_b32 v10, 6, v2
  v_add3_u32 v222, v10, v12, s52
  s_mul_i32 s52, s4, 28
  s_add_u32 s52, s52, s55
  s_lshl_b32 s52, s52, 12
  s_lshl_b32 s53, s54, 7
  s_add_u32 s52, s52, s53
  s_add_u32 s52, s52, 1835008
  v_lshrrev_b32 v10, 5, v1
  v_and_b32 v11, 31, v1
  v_lshrrev_b32 v13, 3, v11
  v_lshlrev_b32 v13, 9, v13
  v_lshl_add_u32 v13, v10, 6, v13
  v_and_b32 v15, 7, v11
  v_lshlrev_b32 v15, 3, v15
  v_add3_u32 v232, v13, v15, s52
  v_add_u32 v233, 28672, v232
  v_add_u32 v234, 57344, v232
  v_add_u32 v235, 86016, v232
  s_lshl_b32 s52, s4, 3
  s_lshl_b32 s53, s54, 1
  s_add_u32 s52, s52, s53
  s_mul_i32 s52, s52, 896
  s_lshl_b32 s53, s55, 7
  s_add_u32 s52, s52, s53
  s_add_u32 s52, s52, 2752512
  v_mul_u32_u24 v13, 896, v10
  v_lshlrev_b32 v15, 2, v11
  v_add3_u32 v223, v13, v15, s52
  s_mul_i32 s52, s4, 7168
  s_mul_i32 s53, s56, 448
  s_add_u32 s52, s52, s53
  s_lshl_b32 s53, s3, 6
  s_add_u32 s52, s52, s53
  s_add_u32 s52, s52, 2752512
  v_mul_u32_u24 v13, 896, v14
  v_add3_u32 v224, v13, v12, s52
  s_mul_i32 s52, s4, 4096
  s_lshl_b32 s53, s5, 7
  s_add_u32 s52, s52, s53
  s_add_u32 s52, s52, 37748736
  v_mul_u32_u24 v13, 262144, v10
  v_lshlrev_b32 v15, 2, v11
  v_add3_u32 v236, v13, v15, s52
  v_add_u32 v237, 32768, v236
  v_add_u32 v238, 65536, v236
  v_add_u32 v239, 98304, v236
  v_add_u32 v240, 131072, v236
  v_add_u32 v241, 163840, v236
  v_add_u32 v242, 196608, v236
  v_add_u32 v243, 229376, v236
  s_lshl_b32 s52, s4, 11
  s_lshl_b32 s53, s5, 6
  s_add_u32 s52, s52, s53
  v_lshlrev_b32 v15, 1, v11
  v_add_u32 v225, s52, v15
  v_add_u32 v226, 162208, v15
  s_cmp_lg_u32 s3, 4
  s_cbranch_scc1 L_rdy_b
  s_cmp_lg_u32 s5, 0
  s_cbranch_scc1 L_rdy_done
  s_lshl_b32 s52, s4, 9
  s_add_u32 s52, s52, 0
  v_and_b32 v10, 31, v1
  v_lshlrev_b32 v10, 4, v10
  v_add_u32 v10, s52, v10
  s_mov_b32 s50, 1048576
L_rdy_1:
  global_load_dwordx4 v[248:251], v10, s[38:39] sc1
  s_waitcnt vmcnt(0)
  v_xor_b32 v11, s66, v250
  v_xor_b32 v15, s67, v251
  v_or_b32 v11, v11, v15
  v_cmp_ne_u32 vcc, 0, v11
  s_cbranch_vccz L_rdyok_2
  s_sleep 16
  s_sub_u32 s50, s50, 1
  s_cmp_lg_u32 s50, 0
  s_cbranch_scc1 L_rdy_1
L_rdyok_2:
  v_readfirstlane_b32 s52, v248
  s_nop 1
  v_cmp_ne_u32 vcc, s52, v248
  s_mov_b32 s54, 1
  s_nop 1
  s_cmp_eq_u64 vcc, 0
  s_cselect_b32 s54, s54, 0
  s_lshl_b32 s52, s4, 4
  s_add_u32 s52, s52, 73728
  v_mov_b32 v10, s52
  v_mov_b32 v12, s54
  v_mov_b32 v13, 0
  v_mov_b32 v14, s66
  v_mov_b32 v15, s67
  s_mov_b32 exec_lo, 1
  s_mov_b32 exec_hi, 0
  global_store_dwordx4 v10, v[12:15], s[38:39] sc1
  s_mov_b64 exec, -1
  s_branch L_rdy_done
L_rdy_b:
  s_cmp_lg_u32 s3, 5
  s_cbranch_scc1 L_rdy_done
  v_and_b32 v10, 7, v1
  v_lshlrev_b32 v10, 4, v10
  v_add_u32 v10, 73728, v10
  s_mov_b32 s50, 1048576
L_grdy_3:
  s_mov_b32 exec_lo, 0xff
  s_mov_b32 exec_hi, 0
  global_load_dwordx4 v[248:251], v10, s[38:39] sc1
  s_waitcnt vmcnt(0)
  v_xor_b32 v11, s66, v250
  v_xor_b32 v15, s67, v251
  v_or_b32 v11, v11, v15
  v_cmp_ne_u32 vcc, 0, v11
  s_mov_b64 exec, -1
  s_cbranch_vccz L_grdyok_4
  s_sleep 64
  s_sub_u32 s50, s50, 1
  s_cmp_lg_u32 s50, 0
  s_cbranch_scc1 L_grdy_3
L_grdyok_4:
  v_readlane_b32 s54, v248, s4
  v_mov_b32 v10, 162320
  s_nop 1
  s_add_u32 s54, s54, 1
  v_mov_b32 v12, s54
  ds_write_b32 v10, v12
L_rdy_done:
  s_branch L_kdone
L_q_01:
  s_lshl_b32 s52, s6, 3
  s_add_u32 s52, s52, s7
  s_lshl_b32 s52, s52, 8
  s_add_u32 s52, s52, 1048576
  v_lshlrev_b32 v10, 2, v1
  v_add_u32 v208, s52, v10
  s_lshl_b32 s52, s3, 9
  s_add_u32 s52, s52, 143360
  v_lshlrev_b32 v11, 5, v2
  v_lshlrev_b32 v12, 4, v3
  v_add3_u32 v227, v11, v12, s52
  v_lshlrev_b32 v11, 3, v1
  v_add_u32 v228, 143360, v11
  v_lshlrev_b32 v11, 3, v3
  v_add_u32 v11, v11, v4
  v_lshlrev_b32 v11, 7, v11
  v_lshlrev_b32 v13, 3, v5
  v_add_u32 v229, v11, v13
  s_lshr_b32 s56, s5, 4
  s_and_b32 s57, s5, 15
  v_and_b32 v14, 7, v1
  s_lshl_b32 s52, s4, 2
  s_lshl_b32 s53, s56, 1
  s_add_u32 s52, s52, s53
  s_lshr_b32 s53, s3, 2
  s_add_u32 s52, s52, s53
  s_lshl_b32 s52, s52, 11
  s_and_b32 s53, s3, 3
  s_lshl_b32 s53, s53, 6
  s_add_u32 s52, s52, s53
  s_add_u32 s52, s52, 1048576
  v_lshlrev_b32 v10, 8, v14
  v_add3_u32 v209, v10, v12, s52
  s_lshl_b32 s52, s3, 11
  s_add_u32 s52, s52, 126976
  v_lshlrev_b32 v10, 8, v2
  v_xor_b32 v11, v3, v5
  v_lshlrev_b32 v11, 4, v11
  v_add3_u32 v210, v10, v11, s52
  s_sub_u32 s52, s3, 2
  s_lshl_b32 s52, s52, 6
  v_add_u32 v10, s52, v1
  v_and_b32 v10, 127, v10
  v_lshrrev_b32 v11, 4, v10
  v_and_b32 v13, 3, v11
  v_xor_b32 v13, v13, v10
  v_lshlrev_b32 v13, 4, v13
  v_add_u32 v211, 126976, v13
  s_lshl_b32 s52, s4, 1
  s_add_u32 s52, s52, s56
  s_mul_i32 s52, s52, 32768
  s_lshl_b32 s53, s57, 8
  s_add_u32 s52, s52, s53
  s_add_u32 s52, s52, 33554432
  v_lshrrev_b32 v11, 4, v10
  v_mul_u32_u24 v11, 4096, v11
  v_lshlrev_b32 v13, 4, v2
  v_add3_u32 v212, v11, v13, s52
  s_lshr_b32 s52, s5, 2
  s_mul_i32 s52, s52, 4096
  s_and_b32 s53, s5, 3
  s_lshl_b32 s53, s53, 10
  s_add_u32 s52, s52, s53
  s_mul_i32 s53, s3, 65536
  s_add_u32 s52, s52, s53
  s_add_u32 s52, s52, 33554432
  v_add_u32 v213, s52, v21
  v_add_u32 v214, 32768, v213
  s_lshl_b32 s52, s3, 10
  s_add_u32 s52, s52, 147456
  v_add_u32 v215, s52, v21
  v_add_u32 v216, 147456, v21
  s_lshr_b32 s52, s5, 2
  s_lshl_b32 s53, s4, 3
  s_add_u32 s52, s52, s53
  s_lshl_b32 s52, s52, 11
  s_and_b32 s53, s5, 3
  s_lshl_b32 s53, s53, 9
  s_add_u32 s52, s52, s53
  s_add_u32 s52, s52, 1703936
  v_lshlrev_b32 v10, 3, v1
  v_add_u32 v217, s52, v10
  s_lshr_b32 s52, s5, 2
  s_lshl_b32 s52, s52, 11
  s_add_u32 s52, s52, s53
  v_add_u32 v9, s52, v10
  s_lshl_b32 s52, s4, 3
  s_add_u32 s52, s52, s3
  s_lshl_b32 s52, s52, 11
  s_add_u32 s52, s52, 1703936
  v_lshlrev_b32 v10, 5, v1
  v_add_u32 v218, s52, v10
  s_mul_i32 s54, s5, 37
  s_lshr_b32 s54, s54, 8
  s_mul_i32 s55, s54, 7
  s_sub_u32 s55, s5, s55
  s_lshl_b32 s52, s54, 4
  v_subrev_u32 v10, s52, v1
  v_cmp_gt_u32 s[8:9], 16, v10
  s_mul_i32 s53, s3, 528
  s_add_u32 s53, s53, 126976
  v_lshlrev_b32 v10, 5, v10
  v_add_u32 v219, s53, v10
  s_lshl_b32 s52, s5, 1
  v_subrev_u32 v10, s52, v1
  v_cmp_gt_u32 s[10:11], 2, v10
  v_lshlrev_b32 v10, 5, v10
  v_add_u32 v220, 162208, v10
  v_mul_u32_u24 v10, 528, v14
  v_add_u32 v10, v10, v12
  v_add_u32 v221, 126976, v10
  s_mul_i32 s52, s4, 28
  s_add_u32 s52, s52, s5
  s_lshl_b32 s52, s52, 12
  s_lshr_b32 s53, s3, 2
  s_lshl_b32 s53, s53, 11
  s_add_u32 s52, s52, s53
  s_and_b32 s53, s3, 3
  s_lshl_b32 s53, s53, 9
  s_add_u32 s52, s52, s53
  s_add_u32 s52, s52, 1835008
  v_lshlrev_b32 v10, 6, v2
  v_add3_u32 v222, v10, v12, s52
  s_mul_i32 s52, s4, 28
  s_add_u32 s52, s52, s55
  s_lshl_b32 s52, s52, 12
  s_lshl_b32 s53, s54, 7
  s_add_u32 s52, s52, s53
  s_add_u32 s52, s52, 1835008
  v_lshrrev_b32 v10, 5, v1
  v_and_b32 v11, 31, v1
  v_lshrrev_b32 v13, 3, v11
  v_lshlrev_b32 v13, 9, v13
  v_lshl_add_u32 v13, v10, 6, v13
  v_and_b32 v15, 7, v11
  v_lshlrev_b32 v15, 3, v15
  v_add3_u32 v232, v13, v15, s52
  v_add_u32 v233, 28672, v232
  v_add_u32 v234, 57344, v232
  v_add_u32 v235, 86016, v232
  s_lshl_b32 s52, s4, 3
  s_lshl_b32 s53, s54, 1
  s_add_u32 s52, s52, s53
  s_mul_i32 s52, s52, 896
  s_lshl_b32 s53, s55, 7
  s_add_u32 s52, s52, s53
  s_add_u32 s52, s52, 2752512
  v_mul_u32_u24 v13, 896, v10
  v_lshlrev_b32 v15, 2, v11
  v_add3_u32 v223, v13, v15, s52
  s_mul_i32 s52, s4, 7168
  s_mul_i32 s53, s56, 448
  s_add_u32 s52, s52, s53
  s_lshl_b32 s53, s3, 6
  s_add_u32 s52, s52, s53
  s_add_u32 s52, s52, 2752512
  v_mul_u32_u24 v13, 896, v14
  v_add3_u32 v224, v13, v12, s52
  s_mul_i32 s52, s4, 4096
  s_lshl_b32 s53, s5, 7
  s_add_u32 s52, s52, s53
  s_add_u32 s52, s52, 37748736
  v_mul_u32_u24 v13, 262144, v10
  v_lshlrev_b32 v15, 2, v11
  v_add3_u32 v236, v13, v15, s52
  v_add_u32 v237, 32768, v236
  v_add_u32 v238, 65536, v236
  v_add_u32 v239, 98304, v236
  v_add_u32 v240, 131072, v236
  v_add_u32 v241, 163840, v236
  v_add_u32 v242, 196608, v236
  v_add_u32 v243, 229376, v236
  s_lshl_b32 s52, s4, 11
  s_lshl_b32 s53, s5, 6
  s_add_u32 s52, s52, s53
  v_lshlrev_b32 v15, 1, v11
  v_add_u32 v225, s52, v15
  v_add_u32 v226, 162208, v15
  s_cmp_eq_u32 s3, 0
  s_cbranch_scc1 L_q_w0
  s_branch L_q_w1
L_prod2:
  v_mov_b32 v10, 162320
  s_mov_b32 s50, 1048576
L_qc_wait:
  s_sleep 16
  ds_read_b32 v11, v10
  s_waitcnt lgkmcnt(0)
  v_readfirstlane_b32 s52, v11
  s_nop 1
  s_cmp_lg_u32 s52, 0
  s_cbranch_scc1 L_qc_go
  s_sub_u32 s50, s50, 1
  s_cmp_lg_u32 s50, 0
  s_cbranch_scc1 L_qc_wait
L_qc_go:
  s_cmp_eq_u32 s52, 2
  s_cbranch_scc1 L_qc_skip
  global_store_dwordx4 v26, v[176:179], s[38:39] offset:0 sc1
  global_store_dwordx4 v26, v[180:183], s[38:39] offset:128 sc1
  global_store_dwordx4 v26, v[184:187], s[38:39] offset:256 sc1
  global_store_dwordx4 v26, v[188:191], s[38:39] offset:384 sc1
L_qc_skip:
L_q_prod2:
  s_lshl_b32 s52, s6, 3
  s_add_u32 s52, s52, s7
  s_lshl_b32 s52, s52, 8
  s_add_u32 s52, s52, 1048576
  v_lshlrev_b32 v10, 2, v1
  v_add_u32 v208, s52, v10
  s_lshl_b32 s52, s3, 9
  s_add_u32 s52, s52, 143360
  v_lshlrev_b32 v11, 5, v2
  v_lshlrev_b32 v12, 4, v3
  v_add3_u32 v227, v11, v12, s52
  v_lshlrev_b32 v11, 3, v1
  v_add_u32 v228, 143360, v11
  v_lshlrev_b32 v11, 3, v3
  v_add_u32 v11, v11, v4
  v_lshlrev_b32 v11, 7, v11
  v_lshlrev_b32 v13, 3, v5
  v_add_u32 v229, v11, v13
  s_lshr_b32 s56, s5, 4
  s_and_b32 s57, s5, 15
  v_and_b32 v14, 7, v1
  s_lshl_b32 s52, s4, 2
  s_lshl_b32 s53, s56, 1
  s_add_u32 s52, s52, s53
  s_lshr_b32 s53, s3, 2
  s_add_u32 s52, s52, s53
  s_lshl_b32 s52, s52, 11
  s_and_b32 s53, s3, 3
  s_lshl_b32 s53, s53, 6
  s_add_u32 s52, s52, s53
  s_add_u32 s52, s52, 1048576
  v_lshlrev_b32 v10, 8, v14
  v_add3_u32 v209, v10, v12, s52
  s_lshl_b32 s52, s3, 11
  s_add_u32 s52, s52, 126976
  v_lshlrev_b32 v10, 8, v2
  v_xor_b32 v11, v3, v5
  v_lshlrev_b32 v11, 4, v11
  v_add3_u32 v210, v10, v11, s52
  s_sub_u32 s52, s3, 2
  s_lshl_b32 s52, s52, 6
  v_add_u32 v10, s52, v1
  v_and_b32 v10, 127, v10
  v_lshrrev_b32 v11, 4, v10
  v_and_b32 v13, 3, v11
  v_xor_b32 v13, v13, v10
  v_lshlrev_b32 v13, 4, v13
  v_add_u32 v211, 126976, v13
  s_lshl_b32 s52, s4, 1
  s_add_u32 s52, s52, s56
  s_mul_i32 s52, s52, 32768
  s_lshl_b32 s53, s57, 8
  s_add_u32 s52, s52, s53
  s_add_u32 s52, s52, 33554432
  v_lshrrev_b32 v11, 4, v10
  v_mul_u32_u24 v11, 4096, v11
  v_lshlrev_b32 v13, 4, v2
  v_add3_u32 v212, v11, v13, s52
  s_lshr_b32 s52, s5, 2
  s_mul_i32 s52, s52, 4096
  s_and_b32 s53, s5, 3
  s_lshl_b32 s53, s53, 10
  s_add_u32 s52, s52, s53
  s_mul_i32 s53, s3, 65536
  s_add_u32 s52, s52, s53
  s_add_u32 s52, s52, 33554432
  v_add_u32 v213, s52, v21
  v_add_u32 v214, 32768, v213
  s_lshl_b32 s52, s3, 10
  s_add_u32 s52, s52, 147456
  v_add_u32 v215, s52, v21
  v_add_u32 v216, 147456, v21
  s_lshr_b32 s52, s5, 2
  s_lshl_b32 s53, s4, 3
  s_add_u32 s52, s52, s53
  s_lshl_b32 s52, s52, 11
  s_and_b32 s53, s5, 3
  s_lshl_b32 s53, s53, 9
  s_add_u32 s52, s52, s53
  s_add_u32 s52, s52, 1703936
  v_lshlrev_b32 v10, 3, v1
  v_add_u32 v217, s52, v10
  s_lshr_b32 s52, s5, 2
  s_lshl_b32 s52, s52, 11
  s_add_u32 s52, s52, s53
  v_add_u32 v9, s52, v10
  s_lshl_b32 s52, s4, 3
  s_add_u32 s52, s52, s3
  s_lshl_b32 s52, s52, 11
  s_add_u32 s52, s52, 1703936
  v_lshlrev_b32 v10, 5, v1
  v_add_u32 v218, s52, v10
  s_mul_i32 s54, s5, 37
  s_lshr_b32 s54, s54, 8
  s_mul_i32 s55, s54, 7
  s_sub_u32 s55, s5, s55
  s_lshl_b32 s52, s54, 4
  v_subrev_u32 v10, s52, v1
  v_cmp_gt_u32 s[8:9], 16, v10
  s_mul_i32 s53, s3, 528
  s_add_u32 s53, s53, 126976
  v_lshlrev_b32 v10, 5, v10
  v_add_u32 v219, s53, v10
  s_lshl_b32 s52, s5, 1
  v_subrev_u32 v10, s52, v1
  v_cmp_gt_u32 s[10:11], 2, v10
  v_lshlrev_b32 v10, 5, v10
  v_add_u32 v220, 162208, v10
  v_mul_u32_u24 v10, 528, v14
  v_add_u32 v10, v10, v12
  v_add_u32 v221, 126976, v10
  s_mul_i32 s52, s4, 28
  s_add_u32 s52, s52, s5
  s_lshl_b32 s52, s52, 12
  s_lshr_b32 s53, s3, 2
  s_lshl_b32 s53, s53, 11
  s_add_u32 s52, s52, s53
  s_and_b32 s53, s3, 3
  s_lshl_b32 s53, s53, 9
  s_add_u32 s52, s52, s53
  s_add_u32 s52, s52, 1835008
  v_lshlrev_b32 v10, 6, v2
  v_add3_u32 v222, v10, v12, s52
  s_mul_i32 s52, s4, 28
  s_add_u32 s52, s52, s55
  s_lshl_b32 s52, s52, 12
  s_lshl_b32 s53, s54, 7
  s_add_u32 s52, s52, s53
  s_add_u32 s52, s52, 1835008
  v_lshrrev_b32 v10, 5, v1
  v_and_b32 v11, 31, v1
  v_lshrrev_b32 v13, 3, v11
  v_lshlrev_b32 v13, 9, v13
  v_lshl_add_u32 v13, v10, 6, v13
  v_and_b32 v15, 7, v11
  v_lshlrev_b32 v15, 3, v15
  v_add3_u32 v232, v13, v15, s52
  v_add_u32 v233, 28672, v232
  v_add_u32 v234, 57344, v232
  v_add_u32 v235, 86016, v232
  s_lshl_b32 s52, s4, 3
  s_lshl_b32 s53, s54, 1
  s_add_u32 s52, s52, s53
  s_mul_i32 s52, s52, 896
  s_lshl_b32 s53, s55, 7
  s_add_u32 s52, s52, s53
  s_add_u32 s52, s52, 2752512
  v_mul_u32_u24 v13, 896, v10
  v_lshlrev_b32 v15, 2, v11
  v_add3_u32 v223, v13, v15, s52
  s_mul_i32 s52, s4, 7168
  s_mul_i32 s53, s56, 448
  s_add_u32 s52, s52, s53
  s_lshl_b32 s53, s3, 6
  s_add_u32 s52, s52, s53
  s_add_u32 s52, s52, 2752512
  v_mul_u32_u24 v13, 896, v14
  v_add3_u32 v224, v13, v12, s52
  s_mul_i32 s52, s4, 4096
  s_lshl_b32 s53, s5, 7
  s_add_u32 s52, s52, s53
  s_add_u32 s52, s52, 37748736
  v_mul_u32_u24 v13, 262144, v10
  v_lshlrev_b32 v15, 2, v11
  v_add3_u32 v236, v13, v15, s52
  v_add_u32 v237, 32768, v236
  v_add_u32 v238, 65536, v236
  v_add_u32 v239, 98304, v236
  v_add_u32 v240, 131072, v236
  v_add_u32 v241, 163840, v236
  v_add_u32 v242, 196608, v236
  v_add_u32 v243, 229376, v236
  s_lshl_b32 s52, s4, 11
  s_lshl_b32 s53, s5, 6
  s_add_u32 s52, s52, s53
  v_lshlrev_b32 v15, 1, v11
  v_add_u32 v225, s52, v15
  v_add_u32 v226, 162208, v15
  s_cmp_lg_u32 s3, 2
  s_cbranch_scc1 L_pf1_skip
  s_getpc_b64 s[60:61]
L_pf1:
  s_add_u32 s60, s60, (L_q_ready-L_pf1)&0xffffffff
  s_addc_u32 s61, s61, (L_q_ready-L_pf1)>>32
  v_lshlrev_b32 v10, 6, v1
  s_mov_b32 s52, L_exit-L_q_ready
L_pf1_loop:
  v_cmp_gt_u32 vcc, s52, v10
  s_and_saveexec_b64 s[62:63], vcc
  s_cbranch_execz L_pf1_done
  global_load_dword v11, v10, s[60:61]
  s_mov_b64 exec, s[62:63]
  v_add_u32 v10, 4096, v10
  s_branch L_pf1_loop
L_pf1_done:
  s_mov_b64 exec, s[62:63]
  s_waitcnt vmcnt(0)
L_pf1_skip:
  global_load_dwordx2 v[244:245], v9, s[16:17]
  s_waitcnt vmcnt(0)
  s_branch L_kdone
L_vlate:
  buffer_load_dwordx4 v[136:139], v21, s[44:47], s48 offen offset:2048 nt
  s_mov_b32 s15, 5
  .p2align 6
L_vloopb:
  ds_read_b128 v[68:71], v23 offset:128
  s_waitcnt lgkmcnt(1)
  s_nop 0
  v_and_b32 v56, v64, v16
  v_and_b32 v57, v64, v17
  v_and_b32 v58, v64, v18
  v_and_b32 v59, v64, v19
  s_waitcnt vmcnt(10)
  s_nop 0
  v_mfma_f32_16x16x32_bf16 v[52:55], v[56:59], v[104:107], v[52:55]
  buffer_load_dwordx4 v[104:107], v21, s[44:47], s48 offen offset:3072 nt
  s_add_u32 s48, s48, 8192
  v_and_b32 v60, v65, v16
  v_and_b32 v61, v65, v17
  v_and_b32 v62, v65, v18
  v_and_b32 v63, v65, v19
  s_waitcnt vmcnt(10)
  s_nop 0
  v_mfma_f32_16x16x32_bf16 v[52:55], v[60:63], v[108:111], v[52:55]
  buffer_load_dwordx4 v[108:111], v21, s[44:47], s48 offen offset:0 nt
  v_and_b32 v56, v66, v16
  v_and_b32 v57, v66, v17
  v_and_b32 v58, v66, v18
  v_and_b32 v59, v66, v19
  s_waitcnt vmcnt(10)
  s_nop 0
  v_mfma_f32_16x16x32_bf16 v[52:55], v[56:59], v[112:115], v[52:55]
  buffer_load_dwordx4 v[112:115], v21, s[44:47], s48 offen offset:1024 nt
  v_and_b32 v60, v67, v16
  v_and_b32 v61, v67, v17
  v_and_b32 v62, v67, v18
  v_and_b32 v63, v67, v19
  s_waitcnt vmcnt(10)
  s_nop 0
  v_mfma_f32_16x16x32_bf16 v[52:55], v[60:63], v[116:119], v[52:55]
  buffer_load_dwordx4 v[116:119], v21, s[44:47], s48 offen offset:2048 nt
  ds_read_b128 v[64:67], v23 offset:256
  s_waitcnt lgkmcnt(1)
  s_nop 0
  v_and_b32 v56, v68, v16
  v_and_b32 v57, v68, v17
  v_and_b32 v58, v68, v18
  v_and_b32 v59, v68, v19
  s_waitcnt vmcnt(10)
  s_nop 0
  v_mfma_f32_16x16x32_bf16 v[52:55], v[56:59], v[120:123], v[52:55]
  buffer_load_dwordx4 v[120:123], v21, s[44:47], s48 offen offset:3072 nt
  s_add_u32 s48, s48, 8192
  v_and_b32 v60, v69, v16
  v_and_b32 v61, v69, v17
  v_and_b32 v62, v69, v18
  v_and_b32 v63, v69, v19
  s_waitcnt vmcnt(10)
  s_nop 0
  v_mfma_f32_16x16x32_bf16 v[52:55], v[60:63], v[124:127], v[52:55]
  buffer_load_dwordx4 v[124:127], v21, s[44:47], s48 offen offset:0 nt
  v_and_b32 v56, v70, v16
  v_and_b32 v57, v70, v17
  v_and_b32 v58, v70, v18
  v_and_b32 v59, v70, v19
  s_waitcnt vmcnt(10)
  s_nop 0
  v_mfma_f32_16x16x32_bf16 v[52:55], v[56:59], v[128:131], v[52:55]
  buffer_load_dwordx4 v[128:131], v21, s[44:47], s48 offen offset:1024 nt
  v_and_b32 v60, v71, v16
  v_and_b32 v61, v71, v17
  v_and_b32 v62, v71, v18
  v_and_b32 v63, v71, v19
  s_waitcnt vmcnt(10)
  s_nop 0
  v_mfma_f32_16x16x32_bf16 v[52:55], v[60:63], v[132:135], v[52:55]
  buffer_load_dwordx4 v[132:135], v21, s[44:47], s48 offen offset:2048 nt
  ds_read_b128 v[68:71], v23 offset:384
  s_waitcnt lgkmcnt(1)
  s_nop 0
  v_and_b32 v56, v64, v16
  v_and_b32 v57, v64, v17
  v_and_b32 v58, v64, v18
  v_and_b32 v59, v64, v19
  s_waitcnt vmcnt(10)
  s_nop 0
  v_mfma_f32_16x16x32_bf16 v[52:55], v[56:59], v[96:99], v[52:55]
  buffer_load_dwordx4 v[96:99], v21, s[44:47], s48 offen offset:3072 nt
  s_add_u32 s48, s48, 8192
  v_and_b32 v60, v65, v16
  v_and_b32 v61, v65, v17
  v_and_b32 v62, v65, v18
  v_and_b32 v63, v65, v19
  s_waitcnt vmcnt(10)
  s_nop 0
  v_mfma_f32_16x16x32_bf16 v[52:55], v[60:63], v[100:103], v[52:55]
  buffer_load_dwordx4 v[100:103], v21, s[44:47], s48 offen offset:0 nt
  v_and_b32 v56, v66, v16
  v_and_b32 v57, v66, v17
  v_and_b32 v58, v66, v18
  v_and_b32 v59, v66, v19
  s_waitcnt vmcnt(10)
  s_nop 0
  v_mfma_f32_16x16x32_bf16 v[52:55], v[56:59], v[136:139], v[52:55]
  buffer_load_dwordx4 v[136:139], v21, s[44:47], s48 offen offset:1024 nt
  v_and_b32 v60, v67, v16
  v_and_b32 v61, v67, v17
  v_and_b32 v62, v67, v18
  v_and_b32 v63, v67, v19
  s_waitcnt vmcnt(10)
  s_nop 0
  v_mfma_f32_16x16x32_bf16 v[52:55], v[60:63], v[104:107], v[52:55]
  buffer_load_dwordx4 v[104:107], v21, s[44:47], s48 offen offset:2048 nt
  ds_read_b128 v[64:67], v23 offset:512
  s_waitcnt lgkmcnt(1)
  s_nop 0
  v_and_b32 v56, v68, v16
  v_and_b32 v57, v68, v17
  v_and_b32 v58, v68, v18
  v_and_b32 v59, v68, v19
  s_waitcnt vmcnt(10)
  s_nop 0
  v_mfma_f32_16x16x32_bf16 v[52:55], v[56:59], v[108:111], v[52:55]
  buffer_load_dwordx4 v[108:111], v21, s[44:47], s48 offen offset:3072 nt
  s_add_u32 s48, s48, 8192
  v_and_b32 v60, v69, v16
  v_and_b32 v61, v69, v17
  v_and_b32 v62, v69, v18
  v_and_b32 v63, v69, v19
  s_waitcnt vmcnt(10)
  s_nop 0
  v_mfma_f32_16x16x32_bf16 v[52:55], v[60:63], v[112:115], v[52:55]
  buffer_load_dwordx4 v[112:115], v21, s[44:47], s48 offen offset:0 nt
  v_and_b32 v56, v70, v16
  v_and_b32 v57, v70, v17
  v_and_b32 v58, v70, v18
  v_and_b32 v59, v70, v19
  s_waitcnt vmcnt(10)
  s_nop 0
  v_mfma_f32_16x16x32_bf16 v[52:55], v[56:59], v[116:119], v[52:55]
  buffer_load_dwordx4 v[116:119], v21, s[44:47], s48 offen offset:1024 nt
  v_and_b32 v60, v71, v16
  v_and_b32 v61, v71, v17
  v_and_b32 v62, v71, v18
  v_and_b32 v63, v71, v19
  s_waitcnt vmcnt(10)
  s_nop 0
  v_mfma_f32_16x16x32_bf16 v[52:55], v[60:63], v[120:123], v[52:55]
  buffer_load_dwordx4 v[120:123], v21, s[44:47], s48 offen offset:2048 nt
  ds_read_b128 v[68:71], v23 offset:640
  s_waitcnt lgkmcnt(1)
  s_nop 0
  v_and_b32 v56, v64, v16
  v_and_b32 v57, v64, v17
  v_and_b32 v58, v64, v18
  v_and_b32 v59, v64, v19
  s_waitcnt vmcnt(10)
  s_nop 0
  v_mfma_f32_16x16x32_bf16 v[52:55], v[56:59], v[124:127], v[52:55]
  buffer_load_dwordx4 v[124:127], v21, s[44:47], s48 offen offset:3072 nt
  s_add_u32 s48, s48, 8192
  v_and_b32 v60, v65, v16
  v_and_b32 v61, v65, v17
  v_and_b32 v62, v65, v18
  v_and_b32 v63, v65, v19
  s_waitcnt vmcnt(10)
  s_nop 0
  v_mfma_f32_16x16x32_bf16 v[52:55], v[60:63], v[128:131], v[52:55]
  buffer_load_dwordx4 v[128:131], v21, s[44:47], s48 offen offset:0 nt
  v_and_b32 v56, v66, v16
  v_and_b32 v57, v66, v17
  v_and_b32 v58, v66, v18
  v_and_b32 v59, v66, v19
  s_waitcnt vmcnt(10)
  s_nop 0
  v_mfma_f32_16x16x32_bf16 v[52:55], v[56:59], v[132:135], v[52:55]
  buffer_load_dwordx4 v[132:135], v21, s[44:47], s48 offen offset:1024 nt
  v_and_b32 v60, v67, v16
  v_and_b32 v61, v67, v17
  v_and_b32 v62, v67, v18
  v_and_b32 v63, v67, v19
  s_waitcnt vmcnt(10)
  s_nop 0
  v_mfma_f32_16x16x32_bf16 v[52:55], v[60:63], v[96:99], v[52:55]
  buffer_load_dwordx4 v[96:99], v21, s[44:47], s48 offen offset:2048 nt
  ds_read_b128 v[64:67], v23 offset:768
  s_waitcnt lgkmcnt(1)
  s_nop 0
  v_and_b32 v56, v68, v16
  v_and_b32 v57, v68, v17
  v_and_b32 v58, v68, v18
  v_and_b32 v59, v68, v19
  s_waitcnt vmcnt(10)
  s_nop 0
  v_mfma_f32_16x16x32_bf16 v[52:55], v[56:59], v[100:103], v[52:55]
  buffer_load_dwordx4 v[100:103], v21, s[44:47], s48 offen offset:3072 nt
  s_add_u32 s48, s48, 8192
  v_and_b32 v60, v69, v16
  v_and_b32 v61, v69, v17
  v_and_b32 v62, v69, v18
  v_and_b32 v63, v69, v19
  s_waitcnt vmcnt(10)
  s_nop 0
  v_mfma_f32_16x16x32_bf16 v[52:55], v[60:63], v[136:139], v[52:55]
  buffer_load_dwordx4 v[136:139], v21, s[44:47], s48 offen offset:0 nt
  v_and_b32 v56, v70, v16
  v_and_b32 v57, v70, v17
  v_and_b32 v58, v70, v18
  v_and_b32 v59, v70, v19
  s_waitcnt vmcnt(10)
  s_nop 0
  v_mfma_f32_16x16x32_bf16 v[52:55], v[56:59], v[104:107], v[52:55]
  buffer_load_dwordx4 v[104:107], v21, s[44:47], s48 offen offset:1024 nt
  v_and_b32 v60, v71, v16
  v_and_b32 v61, v71, v17
  v_and_b32 v62, v71, v18
  v_and_b32 v63, v71, v19
  s_waitcnt vmcnt(10)
  s_nop 0
  v_mfma_f32_16x16x32_bf16 v[52:55], v[60:63], v[108:111], v[52:55]
  buffer_load_dwordx4 v[108:111], v21, s[44:47], s48 offen offset:2048 nt
  ds_read_b128 v[68:71], v23 offset:896
  s_waitcnt lgkmcnt(1)
  s_nop 0
  v_and_b32 v56, v64, v16
  v_and_b32 v57, v64, v17
  v_and_b32 v58, v64, v18
  v_and_b32 v59, v64, v19
  s_waitcnt vmcnt(10)
  s_nop 0
  v_mfma_f32_16x16x32_bf16 v[52:55], v[56:59], v[112:115], v[52:55]
  buffer_load_dwordx4 v[112:115], v21, s[44:47], s48 offen offset:3072 nt
  s_add_u32 s48, s48, 8192
  v_and_b32 v60, v65, v16
  v_and_b32 v61, v65, v17
  v_and_b32 v62, v65, v18
  v_and_b32 v63, v65, v19
  s_waitcnt vmcnt(10)
  s_nop 0
  v_mfma_f32_16x16x32_bf16 v[52:55], v[60:63], v[116:119], v[52:55]
  buffer_load_dwordx4 v[116:119], v21, s[44:47], s48 offen offset:0 nt
  v_and_b32 v56, v66, v16
  v_and_b32 v57, v66, v17
  v_and_b32 v58, v66, v18
  v_and_b32 v59, v66, v19
  s_waitcnt vmcnt(10)
  s_nop 0
  v_mfma_f32_16x16x32_bf16 v[52:55], v[56:59], v[120:123], v[52:55]
  buffer_load_dwordx4 v[120:123], v21, s[44:47], s48 offen offset:1024 nt
  v_and_b32 v60, v67, v16
  v_and_b32 v61, v67, v17
  v_and_b32 v62, v67, v18
  v_and_b32 v63, v67, v19
  s_waitcnt vmcnt(10)
  s_nop 0
  v_mfma_f32_16x16x32_bf16 v[52:55], v[60:63], v[124:127], v[52:55]
  buffer_load_dwordx4 v[124:127], v21, s[44:47], s48 offen offset:2048 nt
  ds_read_b128 v[64:67], v23 offset:1024
  s_waitcnt lgkmcnt(1)
  s_nop 0
  v_and_b32 v56, v68, v16
  v_and_b32 v57, v68, v17
  v_and_b32 v58, v68, v18
  v_and_b32 v59, v68, v19
  s_waitcnt vmcnt(10)
  s_nop 0
  v_mfma_f32_16x16x32_bf16 v[52:55], v[56:59], v[128:131], v[52:55]
  buffer_load_dwordx4 v[128:131], v21, s[44:47], s48 offen offset:3072 nt
  s_add_u32 s48, s48, 8192
  v_and_b32 v60, v69, v16
  v_and_b32 v61, v69, v17
  v_and_b32 v62, v69, v18
  v_and_b32 v63, v69, v19
  s_waitcnt vmcnt(10)
  s_nop 0
  v_mfma_f32_16x16x32_bf16 v[52:55], v[60:63], v[132:135], v[52:55]
  buffer_load_dwordx4 v[132:135], v21, s[44:47], s48 offen offset:0 nt
  v_and_b32 v56, v70, v16
  v_and_b32 v57, v70, v17
  v_and_b32 v58, v70, v18
  v_and_b32 v59, v70, v19
  s_waitcnt vmcnt(10)
  s_nop 0
  v_mfma_f32_16x16x32_bf16 v[52:55], v[56:59], v[96:99], v[52:55]
  buffer_load_dwordx4 v[96:99], v21, s[44:47], s48 offen offset:1024 nt
  v_and_b32 v60, v71, v16
  v_and_b32 v61, v71, v17
  v_and_b32 v62, v71, v18
  v_and_b32 v63, v71, v19
  s_waitcnt vmcnt(10)
  s_nop 0
  v_mfma_f32_16x16x32_bf16 v[52:55], v[60:63], v[100:103], v[52:55]
  buffer_load_dwordx4 v[100:103], v21, s[44:47], s48 offen offset:2048 nt
  ds_read_b128 v[68:71], v23 offset:1152
  s_waitcnt lgkmcnt(1)
  s_nop 0
  v_and_b32 v56, v64, v16
  v_and_b32 v57, v64, v17
  v_and_b32 v58, v64, v18
  v_and_b32 v59, v64, v19
  s_waitcnt vmcnt(10)
  s_nop 0
  v_mfma_f32_16x16x32_bf16 v[52:55], v[56:59], v[136:139], v[52:55]
  buffer_load_dwordx4 v[136:139], v21, s[44:47], s48 offen offset:3072 nt
  s_add_u32 s48, s48, 8192
  v_and_b32 v60, v65, v16
  v_and_b32 v61, v65, v17
  v_and_b32 v62, v65, v18
  v_and_b32 v63, v65, v19
  s_waitcnt vmcnt(10)
  s_nop 0
  v_mfma_f32_16x16x32_bf16 v[52:55], v[60:63], v[104:107], v[52:55]
  buffer_load_dwordx4 v[104:107], v21, s[44:47], s48 offen offset:0 nt
  v_and_b32 v56, v66, v16
  v_and_b32 v57, v66, v17
  v_and_b32 v58, v66, v18
  v_and_b32 v59, v66, v19
  s_waitcnt vmcnt(10)
  s_nop 0
  v_mfma_f32_16x16x32_bf16 v[52:55], v[56:59], v[108:111], v[52:55]
  buffer_load_dwordx4 v[108:111], v21, s[44:47], s48 offen offset:1024 nt
  v_and_b32 v60, v67, v16
  v_and_b32 v61, v67, v17
  v_and_b32 v62, v67, v18
  v_and_b32 v63, v67, v19
  s_waitcnt vmcnt(10)
  s_nop 0
  v_mfma_f32_16x16x32_bf16 v[52:55], v[60:63], v[112:115], v[52:55]
  buffer_load_dwordx4 v[112:115], v21, s[44:47], s48 offen offset:2048 nt
  ds_read_b128 v[64:67], v23 offset:1280
  s_waitcnt lgkmcnt(1)
  s_nop 0
  v_and_b32 v56, v68, v16
  v_and_b32 v57, v68, v17
  v_and_b32 v58, v68, v18
  v_and_b32 v59, v68, v19
  s_waitcnt vmcnt(10)
  s_nop 0
  v_mfma_f32_16x16x32_bf16 v[52:55], v[56:59], v[116:119], v[52:55]
  buffer_load_dwordx4 v[116:119], v21, s[44:47], s48 offen offset:3072 nt
  s_add_u32 s48, s48, 8192
  v_and_b32 v60, v69, v16
  v_and_b32 v61, v69, v17
  v_and_b32 v62, v69, v18
  v_and_b32 v63, v69, v19
  s_waitcnt vmcnt(10)
  s_nop 0
  v_mfma_f32_16x16x32_bf16 v[52:55], v[60:63], v[120:123], v[52:55]
  buffer_load_dwordx4 v[120:123], v21, s[44:47], s48 offen offset:0 nt
  v_and_b32 v56, v70, v16
  v_and_b32 v57, v70, v17
  v_and_b32 v58, v70, v18
  v_and_b32 v59, v70, v19
  s_waitcnt vmcnt(10)
  s_nop 0
  v_mfma_f32_16x16x32_bf16 v[52:55], v[56:59], v[124:127], v[52:55]
  buffer_load_dwordx4 v[124:127], v21, s[44:47], s48 offen offset:1024 nt
  v_and_b32 v60, v71, v16
  v_and_b32 v61, v71, v17
  v_and_b32 v62, v71, v18
  v_and_b32 v63, v71, v19
  s_waitcnt vmcnt(10)
  s_nop 0
  v_mfma_f32_16x16x32_bf16 v[52:55], v[60:63], v[128:131], v[52:55]
  buffer_load_dwordx4 v[128:131], v21, s[44:47], s48 offen offset:2048 nt
  ds_read_b128 v[68:71], v23 offset:1408
  s_waitcnt lgkmcnt(1)
  s_nop 0
  v_and_b32 v56, v64, v16
  v_and_b32 v57, v64, v17
  v_and_b32 v58, v64, v18
  v_and_b32 v59, v64, v19
  s_waitcnt vmcnt(10)
  s_nop 0
  v_mfma_f32_16x16x32_bf16 v[52:55], v[56:59], v[132:135], v[52:55]
  buffer_load_dwordx4 v[132:135], v21, s[44:47], s48 offen offset:3072 nt
  s_add_u32 s48, s48, 8192
  v_and_b32 v60, v65, v16
  v_and_b32 v61, v65, v17
  v_and_b32 v62, v65, v18
  v_and_b32 v63, v65, v19
  s_waitcnt vmcnt(10)
  s_nop 0
  v_mfma_f32_16x16x32_bf16 v[52:55], v[60:63], v[96:99], v[52:55]
  buffer_load_dwordx4 v[96:99], v21, s[44:47], s48 offen offset:0 nt
  v_and_b32 v56, v66, v16
  v_and_b32 v57, v66, v17
  v_and_b32 v58, v66, v18
  v_and_b32 v59, v66, v19
  s_waitcnt vmcnt(10)
  s_nop 0
  v_mfma_f32_16x16x32_bf16 v[52:55], v[56:59], v[100:103], v[52:55]
  buffer_load_dwordx4 v[100:103], v21, s[44:47], s48 offen offset:1024 nt
  v_and_b32 v60, v67, v16
  v_and_b32 v61, v67, v17
  v_and_b32 v62, v67, v18
  v_and_b32 v63, v67, v19
  s_waitcnt vmcnt(10)
  s_nop 0
  v_mfma_f32_16x16x32_bf16 v[52:55], v[60:63], v[136:139], v[52:55]
  buffer_load_dwordx4 v[136:139], v21, s[44:47], s48 offen offset:2048 nt
  ds_read_b128 v[64:67], v23 offset:1536
  s_waitcnt lgkmcnt(1)
  s_nop 0
  v_and_b32 v56, v68, v16
  v_and_b32 v57, v68, v17
  v_and_b32 v58, v68, v18
  v_and_b32 v59, v68, v19
  s_waitcnt vmcnt(10)
  s_nop 0
  v_mfma_f32_16x16x32_bf16 v[52:55], v[56:59], v[104:107], v[52:55]
  buffer_load_dwordx4 v[104:107], v21, s[44:47], s48 offen offset:3072 nt
  s_add_u32 s48, s48, 8192
  v_and_b32 v60, v69, v16
  v_and_b32 v61, v69, v17
  v_and_b32 v62, v69, v18
  v_and_b32 v63, v69, v19
  s_waitcnt vmcnt(10)
  s_nop 0
  v_mfma_f32_16x16x32_bf16 v[52:55], v[60:63], v[108:111], v[52:55]
  buffer_load_dwordx4 v[108:111], v21, s[44:47], s48 offen offset:0 nt
  v_and_b32 v56, v70, v16
  v_and_b32 v57, v70, v17
  v_and_b32 v58, v70, v18
  v_and_b32 v59, v70, v19
  s_waitcnt vmcnt(10)
  s_nop 0
  v_mfma_f32_16x16x32_bf16 v[52:55], v[56:59], v[112:115], v[52:55]
  buffer_load_dwordx4 v[112:115], v21, s[44:47], s48 offen offset:1024 nt
  v_and_b32 v60, v71, v16
  v_and_b32 v61, v71, v17
  v_and_b32 v62, v71, v18
  v_and_b32 v63, v71, v19
  s_waitcnt vmcnt(10)
  s_nop 0
  v_mfma_f32_16x16x32_bf16 v[52:55], v[60:63], v[116:119], v[52:55]
  buffer_load_dwordx4 v[116:119], v21, s[44:47], s48 offen offset:2048 nt
  ds_read_b128 v[68:71], v23 offset:1664
  s_waitcnt lgkmcnt(1)
  s_nop 0
  v_and_b32 v56, v64, v16
  v_and_b32 v57, v64, v17
  v_and_b32 v58, v64, v18
  v_and_b32 v59, v64, v19
  s_waitcnt vmcnt(10)
  s_nop 0
  v_mfma_f32_16x16x32_bf16 v[52:55], v[56:59], v[120:123], v[52:55]
  buffer_load_dwordx4 v[120:123], v21, s[44:47], s48 offen offset:3072 nt
  s_add_u32 s48, s48, 8192
  v_and_b32 v60, v65, v16
  v_and_b32 v61, v65, v17
  v_and_b32 v62, v65, v18
  v_and_b32 v63, v65, v19
  s_waitcnt vmcnt(10)
  s_nop 0
  v_mfma_f32_16x16x32_bf16 v[52:55], v[60:63], v[124:127], v[52:55]
  buffer_load_dwordx4 v[124:127], v21, s[44:47], s48 offen offset:0 nt
  v_and_b32 v56, v66, v16
  v_and_b32 v57, v66, v17
  v_and_b32 v58, v66, v18
  v_and_b32 v59, v66, v19
  s_waitcnt vmcnt(10)
  s_nop 0
  v_mfma_f32_16x16x32_bf16 v[52:55], v[56:59], v[128:131], v[52:55]
  buffer_load_dwordx4 v[128:131], v21, s[44:47], s48 offen offset:1024 nt
  v_and_b32 v60, v67, v16
  v_and_b32 v61, v67, v17
  v_and_b32 v62, v67, v18
  v_and_b32 v63, v67, v19
  s_waitcnt vmcnt(10)
  s_nop 0
  v_mfma_f32_16x16x32_bf16 v[52:55], v[60:63], v[132:135], v[52:55]
  buffer_load_dwordx4 v[132:135], v21, s[44:47], s48 offen offset:2048 nt
  ds_read_b128 v[64:67], v23 offset:1792
  s_waitcnt lgkmcnt(1)
  s_nop 0
  v_and_b32 v56, v68, v16
  v_and_b32 v57, v68, v17
  v_and_b32 v58, v68, v18
  v_and_b32 v59, v68, v19
  s_waitcnt vmcnt(10)
  s_nop 0
  v_mfma_f32_16x16x32_bf16 v[52:55], v[56:59], v[96:99], v[52:55]
  buffer_load_dwordx4 v[96:99], v21, s[44:47], s48 offen offset:3072 nt
  s_add_u32 s48, s48, 8192
  v_and_b32 v60, v69, v16
  v_and_b32 v61, v69, v17
  v_and_b32 v62, v69, v18
  v_and_b32 v63, v69, v19
  s_waitcnt vmcnt(10)
  s_nop 0
  v_mfma_f32_16x16x32_bf16 v[52:55], v[60:63], v[100:103], v[52:55]
  buffer_load_dwordx4 v[100:103], v21, s[44:47], s48 offen offset:0 nt
  v_and_b32 v56, v70, v16
  v_and_b32 v57, v70, v17
  v_and_b32 v58, v70, v18
  v_and_b32 v59, v70, v19
  s_waitcnt vmcnt(10)
  s_nop 0
  v_mfma_f32_16x16x32_bf16 v[52:55], v[56:59], v[136:139], v[52:55]
  buffer_load_dwordx4 v[136:139], v21, s[44:47], s48 offen offset:1024 nt
  v_and_b32 v60, v71, v16
  v_and_b32 v61, v71, v17
  v_and_b32 v62, v71, v18
  v_and_b32 v63, v71, v19
  s_waitcnt vmcnt(10)
  s_nop 0
  v_mfma_f32_16x16x32_bf16 v[52:55], v[60:63], v[104:107], v[52:55]
  buffer_load_dwordx4 v[104:107], v21, s[44:47], s48 offen offset:2048 nt
  ds_read_b128 v[68:71], v23 offset:1920
  s_waitcnt lgkmcnt(1)
  s_nop 0
  v_and_b32 v56, v64, v16
  v_and_b32 v57, v64, v17
  v_and_b32 v58, v64, v18
  v_and_b32 v59, v64, v19
  s_waitcnt vmcnt(10)
  s_nop 0
  v_mfma_f32_16x16x32_bf16 v[52:55], v[56:59], v[108:111], v[52:55]
  buffer_load_dwordx4 v[108:111], v21, s[44:47], s48 offen offset:3072 nt
  s_add_u32 s48, s48, 8192
  v_and_b32 v60, v65, v16
  v_and_b32 v61, v65, v17
  v_and_b32 v62, v65, v18
  v_and_b32 v63, v65, v19
  s_waitcnt vmcnt(10)
  s_nop 0
  v_mfma_f32_16x16x32_bf16 v[52:55], v[60:63], v[112:115], v[52:55]
  buffer_load_dwordx4 v[112:115], v21, s[44:47], s48 offen offset:0 nt
  v_and_b32 v56, v66, v16
  v_and_b32 v57, v66, v17
  v_and_b32 v58, v66, v18
  v_and_b32 v59, v66, v19
  s_waitcnt vmcnt(10)
  s_nop 0
  v_mfma_f32_16x16x32_bf16 v[52:55], v[56:59], v[116:119], v[52:55]
  buffer_load_dwordx4 v[116:119], v21, s[44:47], s48 offen offset:1024 nt
  v_and_b32 v60, v67, v16
  v_and_b32 v61, v67, v17
  v_and_b32 v62, v67, v18
  v_and_b32 v63, v67, v19
  s_waitcnt vmcnt(10)
  s_nop 0
  v_mfma_f32_16x16x32_bf16 v[52:55], v[60:63], v[120:123], v[52:55]
  buffer_load_dwordx4 v[120:123], v21, s[44:47], s48 offen offset:2048 nt
  ds_read_b128 v[64:67], v23 offset:2048
  s_waitcnt lgkmcnt(1)
  s_nop 0
  v_and_b32 v56, v68, v16
  v_and_b32 v57, v68, v17
  v_and_b32 v58, v68, v18
  v_and_b32 v59, v68, v19
  s_waitcnt vmcnt(10)
  s_nop 0
  v_mfma_f32_16x16x32_bf16 v[52:55], v[56:59], v[124:127], v[52:55]
  buffer_load_dwordx4 v[124:127], v21, s[44:47], s48 offen offset:3072 nt
  s_add_u32 s48, s48, 8192
  v_and_b32 v60, v69, v16
  v_and_b32 v61, v69, v17
  v_and_b32 v62, v69, v18
  v_and_b32 v63, v69, v19
  s_waitcnt vmcnt(10)
  s_nop 0
  v_mfma_f32_16x16x32_bf16 v[52:55], v[60:63], v[128:131], v[52:55]
  buffer_load_dwordx4 v[128:131], v21, s[44:47], s48 offen offset:0 nt
  v_and_b32 v56, v70, v16
  v_and_b32 v57, v70, v17
  v_and_b32 v58, v70, v18
  v_and_b32 v59, v70, v19
  s_waitcnt vmcnt(10)
  s_nop 0
  v_mfma_f32_16x16x32_bf16 v[52:55], v[56:59], v[132:135], v[52:55]
  buffer_load_dwordx4 v[132:135], v21, s[44:47], s48 offen offset:1024 nt
  v_and_b32 v60, v71, v16
  v_and_b32 v61, v71, v17
  v_and_b32 v62, v71, v18
  v_and_b32 v63, v71, v19
  s_waitcnt vmcnt(10)
  s_nop 0
  v_mfma_f32_16x16x32_bf16 v[52:55], v[60:63], v[96:99], v[52:55]
  buffer_load_dwordx4 v[96:99], v21, s[44:47], s48 offen offset:2048 nt
  ds_read_b128 v[68:71], v23 offset:2176
  s_waitcnt lgkmcnt(1)
  s_nop 0
  v_and_b32 v56, v64, v16
  v_and_b32 v57, v64, v17
  v_and_b32 v58, v64, v18
  v_and_b32 v59, v64, v19
  s_waitcnt vmcnt(10)
  s_nop 0
  v_mfma_f32_16x16x32_bf16 v[52:55], v[56:59], v[100:103], v[52:55]
  buffer_load_dwordx4 v[100:103], v21, s[44:47], s48 offen offset:3072 nt
  s_add_u32 s48, s48, 8192
  v_and_b32 v60, v65, v16
  v_and_b32 v61, v65, v17
  v_and_b32 v62, v65, v18
  v_and_b32 v63, v65, v19
  s_waitcnt vmcnt(10)
  s_nop 0
  v_mfma_f32_16x16x32_bf16 v[52:55], v[60:63], v[136:139], v[52:55]
  buffer_load_dwordx4 v[136:139], v21, s[44:47], s48 offen offset:0 nt
  v_and_b32 v56, v66, v16
  v_and_b32 v57, v66, v17
  v_and_b32 v58, v66, v18
  v_and_b32 v59, v66, v19
  s_waitcnt vmcnt(10)
  s_nop 0
  v_mfma_f32_16x16x32_bf16 v[52:55], v[56:59], v[104:107], v[52:55]
  buffer_load_dwordx4 v[104:107], v21, s[44:47], s48 offen offset:1024 nt
  v_and_b32 v60, v67, v16
  v_and_b32 v61, v67, v17
  v_and_b32 v62, v67, v18
  v_and_b32 v63, v67, v19
  s_waitcnt vmcnt(10)
  s_nop 0
  v_mfma_f32_16x16x32_bf16 v[52:55], v[60:63], v[108:111], v[52:55]
  buffer_load_dwordx4 v[108:111], v21, s[44:47], s48 offen offset:2048 nt
  ds_read_b128 v[64:67], v23 offset:2304
  s_waitcnt lgkmcnt(1)
  s_nop 0
  v_and_b32 v56, v68, v16
  v_and_b32 v57, v68, v17
  v_and_b32 v58, v68, v18
  v_and_b32 v59, v68, v19
  s_waitcnt vmcnt(10)
  s_nop 0
  v_mfma_f32_16x16x32_bf16 v[52:55], v[56:59], v[112:115], v[52:55]
  buffer_load_dwordx4 v[112:115], v21, s[44:47], s48 offen offset:3072 nt
  s_add_u32 s48, s48, 8192
  v_and_b32 v60, v69, v16
  v_and_b32 v61, v69, v17
  v_and_b32 v62, v69, v18
  v_and_b32 v63, v69, v19
  s_waitcnt vmcnt(10)
  s_nop 0
  v_mfma_f32_16x16x32_bf16 v[52:55], v[60:63], v[116:119], v[52:55]
  buffer_load_dwordx4 v[116:119], v21, s[44:47], s48 offen offset:0 nt
  v_and_b32 v56, v70, v16
  v_and_b32 v57, v70, v17
  v_and_b32 v58, v70, v18
  v_and_b32 v59, v70, v19
  s_waitcnt vmcnt(10)
  s_nop 0
  v_mfma_f32_16x16x32_bf16 v[52:55], v[56:59], v[120:123], v[52:55]
  buffer_load_dwordx4 v[120:123], v21, s[44:47], s48 offen offset:1024 nt
  v_and_b32 v60, v71, v16
  v_and_b32 v61, v71, v17
  v_and_b32 v62, v71, v18
  v_and_b32 v63, v71, v19
  s_waitcnt vmcnt(10)
  s_nop 0
  v_mfma_f32_16x16x32_bf16 v[52:55], v[60:63], v[124:127], v[52:55]
  buffer_load_dwordx4 v[124:127], v21, s[44:47], s48 offen offset:2048 nt
  ds_read_b128 v[68:71], v23 offset:2432
  s_waitcnt lgkmcnt(1)
  s_nop 0
  v_and_b32 v56, v64, v16
  v_and_b32 v57, v64, v17
  v_and_b32 v58, v64, v18
  v_and_b32 v59, v64, v19
  s_waitcnt vmcnt(10)
  s_nop 0
  v_mfma_f32_16x16x32_bf16 v[52:55], v[56:59], v[128:131], v[52:55]
  buffer_load_dwordx4 v[128:131], v21, s[44:47], s48 offen offset:3072 nt
  s_add_u32 s48, s48, 8192
  v_and_b32 v60, v65, v16
  v_and_b32 v61, v65, v17
  v_and_b32 v62, v65, v18
  v_and_b32 v63, v65, v19
  s_waitcnt vmcnt(10)
  s_nop 0
  v_mfma_f32_16x16x32_bf16 v[52:55], v[60:63], v[132:135], v[52:55]
  buffer_load_dwordx4 v[132:135], v21, s[44:47], s48 offen offset:0 nt
  v_and_b32 v56, v66, v16
  v_and_b32 v57, v66, v17
  v_and_b32 v58, v66, v18
  v_and_b32 v59, v66, v19
  s_waitcnt vmcnt(10)
  s_nop 0
  v_mfma_f32_16x16x32_bf16 v[52:55], v[56:59], v[96:99], v[52:55]
  buffer_load_dwordx4 v[96:99], v21, s[44:47], s48 offen offset:1024 nt
  v_and_b32 v60, v67, v16
  v_and_b32 v61, v67, v17
  v_and_b32 v62, v67, v18
  v_and_b32 v63, v67, v19
  s_waitcnt vmcnt(10)
  s_nop 0
  v_mfma_f32_16x16x32_bf16 v[52:55], v[60:63], v[100:103], v[52:55]
  buffer_load_dwordx4 v[100:103], v21, s[44:47], s48 offen offset:2048 nt
  ds_read_b128 v[64:67], v23 offset:2560
  s_waitcnt lgkmcnt(1)
  s_nop 0
  v_and_b32 v56, v68, v16
  v_and_b32 v57, v68, v17
  v_and_b32 v58, v68, v18
  v_and_b32 v59, v68, v19
  s_waitcnt vmcnt(10)
  s_nop 0
  v_mfma_f32_16x16x32_bf16 v[52:55], v[56:59], v[136:139], v[52:55]
  buffer_load_dwordx4 v[136:139], v21, s[44:47], s48 offen offset:3072 nt
  s_add_u32 s48, s48, 8192
  v_and_b32 v60, v69, v16
  v_and_b32 v61, v69, v17
  v_and_b32 v62, v69, v18
  v_and_b32 v63, v69, v19
  s_waitcnt vmcnt(10)
  s_nop 0
  v_mfma_f32_16x16x32_bf16 v[52:55], v[60:63], v[104:107], v[52:55]
  buffer_load_dwordx4 v[104:107], v21, s[44:47], s48 offen offset:0 nt
  v_and_b32 v56, v70, v16
  v_and_b32 v57, v70, v17
  v_and_b32 v58, v70, v18
  v_and_b32 v59, v70, v19
  s_waitcnt vmcnt(10)
  s_nop 0
  v_mfma_f32_16x16x32_bf16 v[52:55], v[56:59], v[108:111], v[52:55]
  buffer_load_dwordx4 v[108:111], v21, s[44:47], s48 offen offset:1024 nt
  v_and_b32 v60, v71, v16
  v_and_b32 v61, v71, v17
  v_and_b32 v62, v71, v18
  v_and_b32 v63, v71, v19
  s_waitcnt vmcnt(10)
  s_nop 0
  v_mfma_f32_16x16x32_bf16 v[52:55], v[60:63], v[112:115], v[52:55]
  buffer_load_dwordx4 v[112:115], v21, s[44:47], s48 offen offset:2048 nt
  ds_read_b128 v[68:71], v23 offset:2688
  s_waitcnt lgkmcnt(1)
  s_nop 0
  v_and_b32 v56, v64, v16
  v_and_b32 v57, v64, v17
  v_and_b32 v58, v64, v18
  v_and_b32 v59, v64, v19
  s_waitcnt vmcnt(10)
  s_nop 0
  v_mfma_f32_16x16x32_bf16 v[52:55], v[56:59], v[116:119], v[52:55]
  buffer_load_dwordx4 v[116:119], v21, s[44:47], s48 offen offset:3072 nt
  s_add_u32 s48, s48, 8192
  v_and_b32 v60, v65, v16
  v_and_b32 v61, v65, v17
  v_and_b32 v62, v65, v18
  v_and_b32 v63, v65, v19
  s_waitcnt vmcnt(10)
  s_nop 0
  v_mfma_f32_16x16x32_bf16 v[52:55], v[60:63], v[120:123], v[52:55]
  buffer_load_dwordx4 v[120:123], v21, s[44:47], s48 offen offset:0 nt
  v_and_b32 v56, v66, v16
  v_and_b32 v57, v66, v17
  v_and_b32 v58, v66, v18
  v_and_b32 v59, v66, v19
  s_waitcnt vmcnt(10)
  s_nop 0
  v_mfma_f32_16x16x32_bf16 v[52:55], v[56:59], v[124:127], v[52:55]
  buffer_load_dwordx4 v[124:127], v21, s[44:47], s48 offen offset:1024 nt
  v_and_b32 v60, v67, v16
  v_and_b32 v61, v67, v17
  v_and_b32 v62, v67, v18
  v_and_b32 v63, v67, v19
  s_waitcnt vmcnt(10)
  s_nop 0
  v_mfma_f32_16x16x32_bf16 v[52:55], v[60:63], v[128:131], v[52:55]
  buffer_load_dwordx4 v[128:131], v21, s[44:47], s48 offen offset:2048 nt
  ds_read_b128 v[64:67], v23 offset:2816
  s_waitcnt lgkmcnt(1)
  s_nop 0
  v_and_b32 v56, v68, v16
  v_and_b32 v57, v68, v17
  v_and_b32 v58, v68, v18
  v_and_b32 v59, v68, v19
  s_waitcnt vmcnt(10)
  s_nop 0
  v_mfma_f32_16x16x32_bf16 v[52:55], v[56:59], v[132:135], v[52:55]
  buffer_load_dwordx4 v[132:135], v21, s[44:47], s48 offen offset:3072 nt
  s_add_u32 s48, s48, 8192
  v_and_b32 v60, v69, v16
  v_and_b32 v61, v69, v17
  v_and_b32 v62, v69, v18
  v_and_b32 v63, v69, v19
  s_waitcnt vmcnt(10)
  s_nop 0
  v_mfma_f32_16x16x32_bf16 v[52:55], v[60:63], v[96:99], v[52:55]
  buffer_load_dwordx4 v[96:99], v21, s[44:47], s48 offen offset:0 nt
  v_and_b32 v56, v70, v16
  v_and_b32 v57, v70, v17
  v_and_b32 v58, v70, v18
  v_and_b32 v59, v70, v19
  s_waitcnt vmcnt(10)
  s_nop 0
  v_mfma_f32_16x16x32_bf16 v[52:55], v[56:59], v[100:103], v[52:55]
  buffer_load_dwordx4 v[100:103], v21, s[44:47], s48 offen offset:1024 nt
  v_and_b32 v60, v71, v16
  v_and_b32 v61, v71, v17
  v_and_b32 v62, v71, v18
  v_and_b32 v63, v71, v19
  s_waitcnt vmcnt(10)
  s_nop 0
  v_mfma_f32_16x16x32_bf16 v[52:55], v[60:63], v[136:139], v[52:55]
  buffer_load_dwordx4 v[136:139], v21, s[44:47], s48 offen offset:2048 nt
  v_add_u32 v23, 2816, v23
  s_sub_u32 s15, s15, 1
  s_cmp_lg_u32 s15, 0
  s_cbranch_scc1 L_vloopb
  ds_read_b128 v[68:71], v23 offset:128
  s_waitcnt lgkmcnt(1)
  s_nop 0
  v_and_b32 v56, v64, v16
  v_and_b32 v57, v64, v17
  v_and_b32 v58, v64, v18
  v_and_b32 v59, v64, v19
  s_waitcnt vmcnt(10)
  s_nop 0
  v_mfma_f32_16x16x32_bf16 v[52:55], v[56:59], v[104:107], v[52:55]
  buffer_load_dwordx4 v[104:107], v21, s[44:47], s48 offen offset:3072 nt
  s_add_u32 s48, s48, 8192
  v_and_b32 v60, v65, v16
  v_and_b32 v61, v65, v17
  v_and_b32 v62, v65, v18
  v_and_b32 v63, v65, v19
  s_waitcnt vmcnt(10)
  s_nop 0
  v_mfma_f32_16x16x32_bf16 v[52:55], v[60:63], v[108:111], v[52:55]
  buffer_load_dwordx4 v[108:111], v21, s[44:47], s48 offen offset:0 nt
  v_and_b32 v56, v66, v16
  v_and_b32 v57, v66, v17
  v_and_b32 v58, v66, v18
  v_and_b32 v59, v66, v19
  s_waitcnt vmcnt(10)
  s_nop 0
  v_mfma_f32_16x16x32_bf16 v[52:55], v[56:59], v[112:115], v[52:55]
  buffer_load_dwordx4 v[112:115], v21, s[44:47], s48 offen offset:1024 nt
  v_and_b32 v60, v67, v16
  v_and_b32 v61, v67, v17
  v_and_b32 v62, v67, v18
  v_and_b32 v63, v67, v19
  s_waitcnt vmcnt(10)
  s_nop 0
  v_mfma_f32_16x16x32_bf16 v[52:55], v[60:63], v[116:119], v[52:55]
  buffer_load_dwordx4 v[116:119], v21, s[44:47], s48 offen offset:2048 nt
  ds_read_b128 v[64:67], v23 offset:256
  s_waitcnt lgkmcnt(1)
  s_nop 0
  v_and_b32 v56, v68, v16
  v_and_b32 v57, v68, v17
  v_and_b32 v58, v68, v18
  v_and_b32 v59, v68, v19
  s_waitcnt vmcnt(10)
  s_nop 0
  v_mfma_f32_16x16x32_bf16 v[52:55], v[56:59], v[120:123], v[52:55]
  buffer_load_dwordx4 v[120:123], v21, s[44:47], s48 offen offset:3072 nt
  s_add_u32 s48, s48, 8192
  v_and_b32 v60, v69, v16
  v_and_b32 v61, v69, v17
  v_and_b32 v62, v69, v18
  v_and_b32 v63, v69, v19
  s_waitcnt vmcnt(10)
  s_nop 0
  v_mfma_f32_16x16x32_bf16 v[52:55], v[60:63], v[124:127], v[52:55]
  buffer_load_dwordx4 v[124:127], v21, s[44:47], s48 offen offset:0 nt
  v_and_b32 v56, v70, v16
  v_and_b32 v57, v70, v17
  v_and_b32 v58, v70, v18
  v_and_b32 v59, v70, v19
  s_waitcnt vmcnt(10)
  s_nop 0
  v_mfma_f32_16x16x32_bf16 v[52:55], v[56:59], v[128:131], v[52:55]
  buffer_load_dwordx4 v[128:131], v21, s[44:47], s48 offen offset:1024 nt
  v_and_b32 v60, v71, v16
  v_and_b32 v61, v71, v17
  v_and_b32 v62, v71, v18
  v_and_b32 v63, v71, v19
  s_waitcnt vmcnt(10)
  s_nop 0
  v_mfma_f32_16x16x32_bf16 v[52:55], v[60:63], v[132:135], v[52:55]
  buffer_load_dwordx4 v[132:135], v21, s[44:47], s48 offen offset:2048 nt
  ds_read_b128 v[68:71], v23 offset:384
  s_waitcnt lgkmcnt(1)
  s_nop 0
  v_and_b32 v56, v64, v16
  v_and_b32 v57, v64, v17
  v_and_b32 v58, v64, v18
  v_and_b32 v59, v64, v19
  s_waitcnt vmcnt(10)
  s_nop 0
  v_mfma_f32_16x16x32_bf16 v[52:55], v[56:59], v[96:99], v[52:55]
  buffer_load_dwordx4 v[96:99], v21, s[44:47], s48 offen offset:3072 nt
  s_add_u32 s48, s48, 8192
  v_and_b32 v60, v65, v16
  v_and_b32 v61, v65, v17
  v_and_b32 v62, v65, v18
  v_and_b32 v63, v65, v19
  s_waitcnt vmcnt(10)
  s_nop 0
  v_mfma_f32_16x16x32_bf16 v[52:55], v[60:63], v[100:103], v[52:55]
  v_and_b32 v56, v66, v16
  v_and_b32 v57, v66, v17
  v_and_b32 v58, v66, v18
  v_and_b32 v59, v66, v19
  s_waitcnt vmcnt(9)
  s_nop 0
  v_mfma_f32_16x16x32_bf16 v[52:55], v[56:59], v[136:139], v[52:55]
  v_and_b32 v60, v67, v16
  v_and_b32 v61, v67, v17
  v_and_b32 v62, v67, v18
  v_and_b32 v63, v67, v19
  s_waitcnt vmcnt(8)
  s_nop 0
  v_mfma_f32_16x16x32_bf16 v[52:55], v[60:63], v[104:107], v[52:55]
  ds_read_b128 v[64:67], v23 offset:512
  s_waitcnt lgkmcnt(1)
  s_nop 0
  v_and_b32 v56, v68, v16
  v_and_b32 v57, v68, v17
  v_and_b32 v58, v68, v18
  v_and_b32 v59, v68, v19
  s_waitcnt vmcnt(7)
  s_nop 0
  v_mfma_f32_16x16x32_bf16 v[52:55], v[56:59], v[108:111], v[52:55]
  v_and_b32 v60, v69, v16
  v_and_b32 v61, v69, v17
  v_and_b32 v62, v69, v18
  v_and_b32 v63, v69, v19
  s_waitcnt vmcnt(6)
  s_nop 0
  v_mfma_f32_16x16x32_bf16 v[52:55], v[60:63], v[112:115], v[52:55]
  v_and_b32 v56, v70, v16
  v_and_b32 v57, v70, v17
  v_and_b32 v58, v70, v18
  v_and_b32 v59, v70, v19
  s_waitcnt vmcnt(5)
  s_nop 0
  v_mfma_f32_16x16x32_bf16 v[52:55], v[56:59], v[116:119], v[52:55]
  v_and_b32 v60, v71, v16
  v_and_b32 v61, v71, v17
  v_and_b32 v62, v71, v18
  v_and_b32 v63, v71, v19
  s_waitcnt vmcnt(4)
  s_nop 0
  v_mfma_f32_16x16x32_bf16 v[52:55], v[60:63], v[120:123], v[52:55]
  s_waitcnt lgkmcnt(0)
  s_nop 0
  v_and_b32 v56, v64, v16
  v_and_b32 v57, v64, v17
  v_and_b32 v58, v64, v18
  v_and_b32 v59, v64, v19
  s_waitcnt vmcnt(3)
  s_nop 0
  v_mfma_f32_16x16x32_bf16 v[52:55], v[56:59], v[124:127], v[52:55]
  v_and_b32 v60, v65, v16
  v_and_b32 v61, v65, v17
  v_and_b32 v62, v65, v18
  v_and_b32 v63, v65, v19
  s_waitcnt vmcnt(2)
  s_nop 0
  v_mfma_f32_16x16x32_bf16 v[52:55], v[60:63], v[128:131], v[52:55]
  v_and_b32 v56, v66, v16
  v_and_b32 v57, v66, v17
  v_and_b32 v58, v66, v18
  v_and_b32 v59, v66, v19
  s_waitcnt vmcnt(1)
  s_nop 0
  v_mfma_f32_16x16x32_bf16 v[52:55], v[56:59], v[132:135], v[52:55]
  v_and_b32 v60, v67, v16
  v_and_b32 v61, v67, v17
  v_and_b32 v62, v67, v18
  v_and_b32 v63, v67, v19
  s_waitcnt vmcnt(0)
  s_nop 0
  v_mfma_f32_16x16x32_bf16 v[52:55], v[60:63], v[96:99], v[52:55]
  s_branch L_vdone
L_codeend:
.section .rodata,"a"
.p2align 6
.amdhsa_kernel sequential_preLN__mha_block_cached__geglu_ffn__decode_kernel
  .amdhsa_next_free_vgpr 256
  .amdhsa_next_free_sgpr 102
  .amdhsa_accum_offset 256
  .amdhsa_group_segment_fixed_size 0
  .amdhsa_kernarg_size 96
  .amdhsa_user_sgpr_count 2
  .amdhsa_user_sgpr_kernarg_segment_ptr 1
  .amdhsa_system_sgpr_workgroup_id_x 1
  .amdhsa_float_denorm_mode_32 3
.end_amdhsa_kernel
```
